```python
import torch

def _softmax(x, axis=-1):
    return torch.softmax(x, dim=axis)
def _gelu(x):
    return torch.nn.functional.gelu(x, approximate="tanh")
def _silu(x):
    return torch.nn.functional.silu(x)
def _sigmoid(x):
    return torch.sigmoid(x)
def _layernorm(x, axis=-1, eps=1e-5):
    m = x.mean(dim=axis, keepdim=True)
    v = x.var(dim=axis, keepdim=True, unbiased=False)
    return (x - m) / torch.sqrt(v + eps)
def _scatter_add(tgt, idx, src, axis=0):
    return tgt.clone().index_add_(axis, idx, src)
def _segment_sum(src, seg, n):
    out = torch.zeros((n,) + src.shape[1:], dtype=src.dtype)
    return out.index_add_(0, seg, src)
def _pad(x, pw):
    flat = tuple(v for pair in reversed(pw) for v in pair)
    return torch.nn.functional.pad(x, flat)

kernel_name = 'standalone__dense_activation_silu__prompt'

def setup_inputs():

    _w = (lambda a: (lambda t: t.to(torch.bfloat16) if t.is_floating_point() else t)(torch.as_tensor(a)))
    B, S, D, F = 1, 2048, 640, 1728
    return {
        "x": _w((lambda *s: torch.randn(*s, dtype=torch.bfloat16) * 0.1)(B, S, D)),
        "w1": _w((lambda *s: torch.randn(*s, dtype=torch.bfloat16) * 3.2)(D, F) * (D ** -0.5)),
        "w2": _w((lambda *s: torch.randn(*s, dtype=torch.bfloat16) * 3.2)(F, D) * (F ** -0.5)),
    }

def reference(x, w1, w2):
    h = torch.einsum("bsd,df->bsf", x, w1)
    h = _silu(h)
    out = torch.einsum("bsf,fd->bsd", h, w2)
    return out
```

```asm
; @launch kernel=gemm1_kernel grid=(256,1,1) block=(256,1,1) lds=131072
; @launch kernel=gemm2_kernel grid=(256,1,1) block=(256,1,1) lds=122880
.amdgcn_target "amdgcn-amd-amdhsa--gfx950"
.text
.globl gemm1_kernel
.p2align 8
.type gemm1_kernel,@function
gemm1_kernel:
    s_cmp_ge_u32 s2, 256
    s_cbranch_scc1 G1_END
    s_load_dwordx4 s[28:31], s[0:1], 0
    s_load_dwordx2 s[32:33], s[0:1], 40
    s_cmp_ge_u32 s2, 224
    s_cbranch_scc1 G1_REPACK
    s_and_b32 s24, s2, 7
    s_lshr_b32 s25, s2, 3
    s_and_b32 s26, s24, 3
    s_lshl_b32 s26, s26, 2
    s_and_b32 s27, s25, 3
    s_add_u32 s26, s26, s27
    s_lshr_b32 s24, s24, 2
    s_mul_i32 s24, s24, 7
    s_lshr_b32 s25, s25, 2
    s_add_u32 s24, s24, s25
    s_lshl_b32 s22, s26, 7
    s_lshl_b32 s23, s24, 7
    v_lshrrev_b32 v1, 6, v0
    v_and_b32 v17, 63, v0
    v_readfirstlane_b32 s21, v1
    v_mov_b32 v1, v17
    v_lshrrev_b32 v18, 3, v1
    v_mul_u32_u24 v18, 0x500, v18
    v_and_b32 v19, 7, v1
    v_lshrrev_b32 v20, 4, v1
    v_xor_b32 v21, v19, v20
    v_lshlrev_b32 v21, 4, v21
    v_add_u32 v2, v18, v21
    v_xor_b32 v21, v19, v20
    v_xor_b32 v21, 4, v21
    v_lshlrev_b32 v21, 4, v21
    v_add_u32 v3, v18, v21
    v_mul_u32_u24 v18, 0xd80, v20
    v_and_b32 v19, 15, v1
    v_lshlrev_b32 v21, 2, v20
    v_xor_b32 v19, v19, v21
    v_lshlrev_b32 v19, 4, v19
    v_add_u32 v4, v18, v19
    s_and_b32 s34, s21, 1
    s_lshr_b32 s35, s21, 1
    s_lshl_b32 s24, s21, 5
    s_add_u32 s24, s24, s22
    s_mul_i32 s17, s24, 1280
    s_mul_i32 s18, s21, 55296
    s_lshl_b32 s24, s23, 1
    s_add_u32 s18, s18, s24
    s_lshl_b32 s19, s21, 12
    s_add_u32 s20, s19, 16384
    v_and_b32 v18, 31, v1
    s_lshl_b32 s24, s34, 6
    v_add_u32 v18, s24, v18
    v_lshrrev_b32 v19, 1, v18
    v_and_b32 v19, 7, v19
    v_lshrrev_b32 v20, 5, v1
    v_xor_b32 v19, v19, v20
    v_lshlrev_b32 v18, 7, v18
    v_xor_b32 v20, 0, v19
    v_lshlrev_b32 v20, 4, v20
    v_add_u32 v5, v18, v20
    v_add_u32 v9, 0x10000, v5
    v_xor_b32 v20, 2, v19
    v_lshlrev_b32 v20, 4, v20
    v_add_u32 v6, v18, v20
    v_add_u32 v10, 0x10000, v6
    v_xor_b32 v20, 4, v19
    v_lshlrev_b32 v20, 4, v20
    v_add_u32 v7, v18, v20
    v_add_u32 v11, 0x10000, v7
    v_xor_b32 v20, 6, v19
    v_lshlrev_b32 v20, 4, v20
    v_add_u32 v8, v18, v20
    v_add_u32 v12, 0x10000, v8
    v_lshrrev_b32 v18, 5, v1
    v_lshlrev_b32 v18, 3, v18
    v_and_b32 v19, 15, v1
    v_lshrrev_b32 v19, 2, v19
    v_add_u32 v18, v18, v19
    v_lshlrev_b32 v18, 8, v18
    v_and_b32 v20, 1, v1
    v_lshlrev_b32 v20, 3, v20
    v_add_u32 v18, v18, v20
    v_add_u32 v18, 0x4000, v18
    v_lshrrev_b32 v20, 4, v1
    v_and_b32 v20, 1, v20
    v_lshlrev_b32 v20, 1, v20
    v_and_b32 v21, 3, v1
    v_lshrrev_b32 v21, 1, v21
    v_add_u32 v20, v20, v21
    s_lshl_b32 s24, s35, 3
    v_add_u32 v20, s24, v20
    v_lshlrev_b32 v19, 2, v19
    v_add_u32 v21, 0, v20
    v_xor_b32 v21, v21, v19
    v_lshlrev_b32 v21, 4, v21
    v_add_u32 v13, v18, v21
    v_add_u32 v15, 0x10000, v13
    v_add_u32 v21, 4, v20
    v_xor_b32 v21, v21, v19
    v_lshlrev_b32 v21, 4, v21
    v_add_u32 v14, v18, v21
    v_add_u32 v16, 0x10000, v14
    s_waitcnt lgkmcnt(0)
    s_mov_b32 s4, s28
    s_and_b32 s5, s29, 0xffff
    s_mov_b32 s6, 2621440
    s_mov_b32 s7, 0x00020000
    s_mov_b32 s8, s30
    s_and_b32 s9, s31, 0xffff
    s_mov_b32 s10, 2211840
    s_mov_b32 s11, 0x00020000
    s_mov_b32 s12, s32
    s_and_b32 s13, s33, 0xffff
    s_mov_b32 s14, 7077888
    s_mov_b32 s15, 0x00020000
    s_mov_b32 s56, s32
    s_and_b32 s57, s33, 0xffff
    s_mov_b32 s58, 10600448
    s_mov_b32 s59, 0x00020000
    s_nop 4
    s_add_u32 m0, s19, 0
    s_add_u32 s16, s17, 0
    buffer_load_dwordx4 v2, s[4:7], s16 offen lds
    s_add_u32 m0, s20, 0
    s_add_u32 s16, s18, 0
    buffer_load_dwordx4 v4, s[8:11], s16 offen lds
    s_add_u32 m0, s19, 1024
    s_add_u32 s16, s17, 10240
    buffer_load_dwordx4 v3, s[4:7], s16 offen lds
    s_add_u32 m0, s20, 1024
    s_add_u32 s16, s18, 13824
    buffer_load_dwordx4 v4, s[8:11], s16 offen lds
    s_add_u32 m0, s19, 2048
    s_add_u32 s16, s17, 20480
    buffer_load_dwordx4 v2, s[4:7], s16 offen lds
    s_add_u32 m0, s20, 2048
    s_add_u32 s16, s18, 27648
    buffer_load_dwordx4 v4, s[8:11], s16 offen lds
    s_add_u32 m0, s19, 3072
    s_add_u32 s16, s17, 30720
    buffer_load_dwordx4 v3, s[4:7], s16 offen lds
    s_add_u32 m0, s20, 3072
    s_add_u32 s16, s18, 41472
    buffer_load_dwordx4 v4, s[8:11], s16 offen lds
    s_add_u32 m0, s19, 32768
    s_add_u32 s16, s17, 128
    buffer_load_dwordx4 v2, s[4:7], s16 offen lds
    s_add_u32 m0, s20, 32768
    s_add_u32 s16, s18, 221184
    buffer_load_dwordx4 v4, s[8:11], s16 offen lds
    s_add_u32 m0, s19, 33792
    s_add_u32 s16, s17, 10368
    buffer_load_dwordx4 v3, s[4:7], s16 offen lds
    s_add_u32 m0, s20, 33792
    s_add_u32 s16, s18, 235008
    buffer_load_dwordx4 v4, s[8:11], s16 offen lds
    s_add_u32 m0, s19, 34816
    s_add_u32 s16, s17, 20608
    buffer_load_dwordx4 v2, s[4:7], s16 offen lds
    s_add_u32 m0, s20, 34816
    s_add_u32 s16, s18, 248832
    buffer_load_dwordx4 v4, s[8:11], s16 offen lds
    s_add_u32 m0, s19, 35840
    s_add_u32 s16, s17, 30848
    buffer_load_dwordx4 v3, s[4:7], s16 offen lds
    s_add_u32 m0, s20, 35840
    s_add_u32 s16, s18, 262656
    buffer_load_dwordx4 v4, s[8:11], s16 offen lds
    s_add_u32 m0, s19, 65536
    s_add_u32 s16, s17, 256
    buffer_load_dwordx4 v2, s[4:7], s16 offen lds
    s_add_u32 m0, s20, 65536
    s_add_u32 s16, s18, 442368
    buffer_load_dwordx4 v4, s[8:11], s16 offen lds
    s_add_u32 m0, s19, 66560
    s_add_u32 s16, s17, 10496
    buffer_load_dwordx4 v3, s[4:7], s16 offen lds
    s_add_u32 m0, s20, 66560
    s_add_u32 s16, s18, 456192
    buffer_load_dwordx4 v4, s[8:11], s16 offen lds
    s_add_u32 m0, s19, 67584
    s_add_u32 s16, s17, 20736
    buffer_load_dwordx4 v2, s[4:7], s16 offen lds
    s_add_u32 m0, s20, 67584
    s_add_u32 s16, s18, 470016
    buffer_load_dwordx4 v4, s[8:11], s16 offen lds
    s_add_u32 m0, s19, 68608
    s_add_u32 s16, s17, 30976
    buffer_load_dwordx4 v3, s[4:7], s16 offen lds
    s_add_u32 m0, s20, 68608
    s_add_u32 s16, s18, 483840
    buffer_load_dwordx4 v4, s[8:11], s16 offen lds
    s_add_u32 m0, s19, 98304
    s_add_u32 s16, s17, 384
    buffer_load_dwordx4 v2, s[4:7], s16 offen lds
    s_add_u32 m0, s20, 98304
    s_add_u32 s16, s18, 663552
    buffer_load_dwordx4 v4, s[8:11], s16 offen lds
    s_waitcnt vmcnt(18)
    s_barrier
    ds_read_b128 v[48:51], v5 offset:0
    ds_read_b64_tr_b16 v[32:33], v13 offset:0
    ds_read_b64_tr_b16 v[34:35], v13 offset:1024
    ds_read_b128 v[52:55], v5 offset:4096
    ds_read_b64_tr_b16 v[36:37], v14 offset:0
    ds_read_b64_tr_b16 v[38:39], v14 offset:1024
    s_waitcnt lgkmcnt(0)
    v_mfma_f32_32x32x16_bf16 v[64:79], v[32:35], v[48:51], 0
    ds_read_b128 v[56:59], v6 offset:0
    ds_read_b64_tr_b16 v[40:41], v13 offset:4096
    v_mfma_f32_32x32x16_bf16 v[80:95], v[32:35], v[52:55], 0
    ds_read_b64_tr_b16 v[42:43], v13 offset:5120
    s_add_u32 m0, s19, 99328
    s_add_u32 s16, s17, 10624
    buffer_load_dwordx4 v3, s[4:7], s16 offen lds
    v_mfma_f32_32x32x16_bf16 v[96:111], v[36:39], v[48:51], 0
    ds_read_b128 v[60:63], v6 offset:4096
    ds_read_b64_tr_b16 v[44:45], v14 offset:4096
    v_mfma_f32_32x32x16_bf16 v[112:127], v[36:39], v[52:55], 0
    ds_read_b64_tr_b16 v[46:47], v14 offset:5120
    s_add_u32 m0, s20, 99328
    s_add_u32 s16, s18, 677376
    buffer_load_dwordx4 v4, s[8:11], s16 offen lds
    s_waitcnt lgkmcnt(0)
    v_mfma_f32_32x32x16_bf16 v[64:79], v[40:43], v[56:59], v[64:79]
    ds_read_b128 v[48:51], v7 offset:0
    ds_read_b64_tr_b16 v[32:33], v13 offset:8192
    v_mfma_f32_32x32x16_bf16 v[80:95], v[40:43], v[60:63], v[80:95]
    ds_read_b64_tr_b16 v[34:35], v13 offset:9216
    s_add_u32 m0, s19, 100352
    s_add_u32 s16, s17, 20864
    buffer_load_dwordx4 v2, s[4:7], s16 offen lds
    v_mfma_f32_32x32x16_bf16 v[96:111], v[44:47], v[56:59], v[96:111]
    ds_read_b128 v[52:55], v7 offset:4096
    ds_read_b64_tr_b16 v[36:37], v14 offset:8192
    v_mfma_f32_32x32x16_bf16 v[112:127], v[44:47], v[60:63], v[112:127]
    ds_read_b64_tr_b16 v[38:39], v14 offset:9216
    s_add_u32 m0, s20, 100352
    s_add_u32 s16, s18, 691200
    buffer_load_dwordx4 v4, s[8:11], s16 offen lds
    s_waitcnt lgkmcnt(0)
    v_mfma_f32_32x32x16_bf16 v[64:79], v[32:35], v[48:51], v[64:79]
    ds_read_b128 v[56:59], v8 offset:0
    ds_read_b64_tr_b16 v[40:41], v13 offset:12288
    v_mfma_f32_32x32x16_bf16 v[80:95], v[32:35], v[52:55], v[80:95]
    ds_read_b64_tr_b16 v[42:43], v13 offset:13312
    s_add_u32 m0, s19, 101376
    s_add_u32 s16, s17, 31104
    buffer_load_dwordx4 v3, s[4:7], s16 offen lds
    v_mfma_f32_32x32x16_bf16 v[96:111], v[36:39], v[48:51], v[96:111]
    ds_read_b128 v[60:63], v8 offset:4096
    ds_read_b64_tr_b16 v[44:45], v14 offset:12288
    v_mfma_f32_32x32x16_bf16 v[112:127], v[36:39], v[52:55], v[112:127]
    ds_read_b64_tr_b16 v[46:47], v14 offset:13312
    s_add_u32 m0, s20, 101376
    s_add_u32 s16, s18, 705024
    buffer_load_dwordx4 v4, s[8:11], s16 offen lds
    s_waitcnt lgkmcnt(0)
    s_waitcnt vmcnt(16)
    s_barrier
    v_mfma_f32_32x32x16_bf16 v[64:79], v[40:43], v[56:59], v[64:79]
    ds_read_b128 v[48:51], v5 offset:32768
    ds_read_b64_tr_b16 v[32:33], v13 offset:32768
    v_mfma_f32_32x32x16_bf16 v[80:95], v[40:43], v[60:63], v[80:95]
    ds_read_b64_tr_b16 v[34:35], v13 offset:33792
    s_add_u32 m0, s19, 0
    s_add_u32 s16, s17, 512
    buffer_load_dwordx4 v2, s[4:7], s16 offen lds
    v_mfma_f32_32x32x16_bf16 v[96:111], v[44:47], v[56:59], v[96:111]
    ds_read_b128 v[52:55], v5 offset:36864
    ds_read_b64_tr_b16 v[36:37], v14 offset:32768
    v_mfma_f32_32x32x16_bf16 v[112:127], v[44:47], v[60:63], v[112:127]
    ds_read_b64_tr_b16 v[38:39], v14 offset:33792
    s_add_u32 m0, s20, 0
    s_add_u32 s16, s18, 884736
    buffer_load_dwordx4 v4, s[8:11], s16 offen lds
    s_waitcnt lgkmcnt(0)
    v_mfma_f32_32x32x16_bf16 v[64:79], v[32:35], v[48:51], v[64:79]
    ds_read_b128 v[56:59], v6 offset:32768
    ds_read_b64_tr_b16 v[40:41], v13 offset:36864
    v_mfma_f32_32x32x16_bf16 v[80:95], v[32:35], v[52:55], v[80:95]
    ds_read_b64_tr_b16 v[42:43], v13 offset:37888
    s_add_u32 m0, s19, 1024
    s_add_u32 s16, s17, 10752
    buffer_load_dwordx4 v3, s[4:7], s16 offen lds
    v_mfma_f32_32x32x16_bf16 v[96:111], v[36:39], v[48:51], v[96:111]
    ds_read_b128 v[60:63], v6 offset:36864
    ds_read_b64_tr_b16 v[44:45], v14 offset:36864
    v_mfma_f32_32x32x16_bf16 v[112:127], v[36:39], v[52:55], v[112:127]
    ds_read_b64_tr_b16 v[46:47], v14 offset:37888
    s_add_u32 m0, s20, 1024
    s_add_u32 s16, s18, 898560
    buffer_load_dwordx4 v4, s[8:11], s16 offen lds
    s_waitcnt lgkmcnt(0)
    v_mfma_f32_32x32x16_bf16 v[64:79], v[40:43], v[56:59], v[64:79]
    ds_read_b128 v[48:51], v7 offset:32768
    ds_read_b64_tr_b16 v[32:33], v13 offset:40960
    v_mfma_f32_32x32x16_bf16 v[80:95], v[40:43], v[60:63], v[80:95]
    ds_read_b64_tr_b16 v[34:35], v13 offset:41984
    s_add_u32 m0, s19, 2048
    s_add_u32 s16, s17, 20992
    buffer_load_dwordx4 v2, s[4:7], s16 offen lds
    v_mfma_f32_32x32x16_bf16 v[96:111], v[44:47], v[56:59], v[96:111]
    ds_read_b128 v[52:55], v7 offset:36864
    ds_read_b64_tr_b16 v[36:37], v14 offset:40960
    v_mfma_f32_32x32x16_bf16 v[112:127], v[44:47], v[60:63], v[112:127]
    ds_read_b64_tr_b16 v[38:39], v14 offset:41984
    s_add_u32 m0, s20, 2048
    s_add_u32 s16, s18, 912384
    buffer_load_dwordx4 v4, s[8:11], s16 offen lds
    s_waitcnt lgkmcnt(0)
    v_mfma_f32_32x32x16_bf16 v[64:79], v[32:35], v[48:51], v[64:79]
    ds_read_b128 v[56:59], v8 offset:32768
    ds_read_b64_tr_b16 v[40:41], v13 offset:45056
    v_mfma_f32_32x32x16_bf16 v[80:95], v[32:35], v[52:55], v[80:95]
    ds_read_b64_tr_b16 v[42:43], v13 offset:46080
    s_add_u32 m0, s19, 3072
    s_add_u32 s16, s17, 31232
    buffer_load_dwordx4 v3, s[4:7], s16 offen lds
    v_mfma_f32_32x32x16_bf16 v[96:111], v[36:39], v[48:51], v[96:111]
    ds_read_b128 v[60:63], v8 offset:36864
    ds_read_b64_tr_b16 v[44:45], v14 offset:45056
    v_mfma_f32_32x32x16_bf16 v[112:127], v[36:39], v[52:55], v[112:127]
    ds_read_b64_tr_b16 v[46:47], v14 offset:46080
    s_add_u32 m0, s20, 3072
    s_add_u32 s16, s18, 926208
    buffer_load_dwordx4 v4, s[8:11], s16 offen lds
    s_waitcnt lgkmcnt(0)
    s_waitcnt vmcnt(16)
    s_barrier
    v_mfma_f32_32x32x16_bf16 v[64:79], v[40:43], v[56:59], v[64:79]
    ds_read_b128 v[48:51], v9 offset:0
    ds_read_b64_tr_b16 v[32:33], v15 offset:0
    v_mfma_f32_32x32x16_bf16 v[80:95], v[40:43], v[60:63], v[80:95]
    ds_read_b64_tr_b16 v[34:35], v15 offset:1024
    s_add_u32 m0, s19, 32768
    s_add_u32 s16, s17, 640
    buffer_load_dwordx4 v2, s[4:7], s16 offen lds
    v_mfma_f32_32x32x16_bf16 v[96:111], v[44:47], v[56:59], v[96:111]
    ds_read_b128 v[52:55], v9 offset:4096
    ds_read_b64_tr_b16 v[36:37], v16 offset:0
    v_mfma_f32_32x32x16_bf16 v[112:127], v[44:47], v[60:63], v[112:127]
    ds_read_b64_tr_b16 v[38:39], v16 offset:1024
    s_add_u32 m0, s20, 32768
    s_add_u32 s16, s18, 1105920
    buffer_load_dwordx4 v4, s[8:11], s16 offen lds
    s_waitcnt lgkmcnt(0)
    v_mfma_f32_32x32x16_bf16 v[64:79], v[32:35], v[48:51], v[64:79]
    ds_read_b128 v[56:59], v10 offset:0
    ds_read_b64_tr_b16 v[40:41], v15 offset:4096
    v_mfma_f32_32x32x16_bf16 v[80:95], v[32:35], v[52:55], v[80:95]
    ds_read_b64_tr_b16 v[42:43], v15 offset:5120
    s_add_u32 m0, s19, 33792
    s_add_u32 s16, s17, 10880
    buffer_load_dwordx4 v3, s[4:7], s16 offen lds
    v_mfma_f32_32x32x16_bf16 v[96:111], v[36:39], v[48:51], v[96:111]
    ds_read_b128 v[60:63], v10 offset:4096
    ds_read_b64_tr_b16 v[44:45], v16 offset:4096
    v_mfma_f32_32x32x16_bf16 v[112:127], v[36:39], v[52:55], v[112:127]
    ds_read_b64_tr_b16 v[46:47], v16 offset:5120
    s_add_u32 m0, s20, 33792
    s_add_u32 s16, s18, 1119744
    buffer_load_dwordx4 v4, s[8:11], s16 offen lds
    s_waitcnt lgkmcnt(0)
    v_mfma_f32_32x32x16_bf16 v[64:79], v[40:43], v[56:59], v[64:79]
    ds_read_b128 v[48:51], v11 offset:0
    ds_read_b64_tr_b16 v[32:33], v15 offset:8192
    v_mfma_f32_32x32x16_bf16 v[80:95], v[40:43], v[60:63], v[80:95]
    ds_read_b64_tr_b16 v[34:35], v15 offset:9216
    s_add_u32 m0, s19, 34816
    s_add_u32 s16, s17, 21120
    buffer_load_dwordx4 v2, s[4:7], s16 offen lds
    v_mfma_f32_32x32x16_bf16 v[96:111], v[44:47], v[56:59], v[96:111]
    ds_read_b128 v[52:55], v11 offset:4096
    ds_read_b64_tr_b16 v[36:37], v16 offset:8192
    v_mfma_f32_32x32x16_bf16 v[112:127], v[44:47], v[60:63], v[112:127]
    ds_read_b64_tr_b16 v[38:39], v16 offset:9216
    s_add_u32 m0, s20, 34816
    s_add_u32 s16, s18, 1133568
    buffer_load_dwordx4 v4, s[8:11], s16 offen lds
    s_waitcnt lgkmcnt(0)
    v_mfma_f32_32x32x16_bf16 v[64:79], v[32:35], v[48:51], v[64:79]
    ds_read_b128 v[56:59], v12 offset:0
    ds_read_b64_tr_b16 v[40:41], v15 offset:12288
    v_mfma_f32_32x32x16_bf16 v[80:95], v[32:35], v[52:55], v[80:95]
    ds_read_b64_tr_b16 v[42:43], v15 offset:13312
    s_add_u32 m0, s19, 35840
    s_add_u32 s16, s17, 31360
    buffer_load_dwordx4 v3, s[4:7], s16 offen lds
    v_mfma_f32_32x32x16_bf16 v[96:111], v[36:39], v[48:51], v[96:111]
    ds_read_b128 v[60:63], v12 offset:4096
    ds_read_b64_tr_b16 v[44:45], v16 offset:12288
    v_mfma_f32_32x32x16_bf16 v[112:127], v[36:39], v[52:55], v[112:127]
    ds_read_b64_tr_b16 v[46:47], v16 offset:13312
    s_add_u32 m0, s20, 35840
    s_add_u32 s16, s18, 1147392
    buffer_load_dwordx4 v4, s[8:11], s16 offen lds
    s_waitcnt lgkmcnt(0)
    s_waitcnt vmcnt(16)
    s_barrier
    v_mfma_f32_32x32x16_bf16 v[64:79], v[40:43], v[56:59], v[64:79]
    ds_read_b128 v[48:51], v9 offset:32768
    ds_read_b64_tr_b16 v[32:33], v15 offset:32768
    v_mfma_f32_32x32x16_bf16 v[80:95], v[40:43], v[60:63], v[80:95]
    ds_read_b64_tr_b16 v[34:35], v15 offset:33792
    s_add_u32 m0, s19, 65536
    s_add_u32 s16, s17, 768
    buffer_load_dwordx4 v2, s[4:7], s16 offen lds
    v_mfma_f32_32x32x16_bf16 v[96:111], v[44:47], v[56:59], v[96:111]
    ds_read_b128 v[52:55], v9 offset:36864
    ds_read_b64_tr_b16 v[36:37], v16 offset:32768
    v_mfma_f32_32x32x16_bf16 v[112:127], v[44:47], v[60:63], v[112:127]
    ds_read_b64_tr_b16 v[38:39], v16 offset:33792
    s_add_u32 m0, s20, 65536
    s_add_u32 s16, s18, 1327104
    buffer_load_dwordx4 v4, s[8:11], s16 offen lds
    s_waitcnt lgkmcnt(0)
    v_mfma_f32_32x32x16_bf16 v[64:79], v[32:35], v[48:51], v[64:79]
    ds_read_b128 v[56:59], v10 offset:32768
    ds_read_b64_tr_b16 v[40:41], v15 offset:36864
    v_mfma_f32_32x32x16_bf16 v[80:95], v[32:35], v[52:55], v[80:95]
    ds_read_b64_tr_b16 v[42:43], v15 offset:37888
    s_add_u32 m0, s19, 66560
    s_add_u32 s16, s17, 11008
    buffer_load_dwordx4 v3, s[4:7], s16 offen lds
    v_mfma_f32_32x32x16_bf16 v[96:111], v[36:39], v[48:51], v[96:111]
    ds_read_b128 v[60:63], v10 offset:36864
    ds_read_b64_tr_b16 v[44:45], v16 offset:36864
    v_mfma_f32_32x32x16_bf16 v[112:127], v[36:39], v[52:55], v[112:127]
    ds_read_b64_tr_b16 v[46:47], v16 offset:37888
    s_add_u32 m0, s20, 66560
    s_add_u32 s16, s18, 1340928
    buffer_load_dwordx4 v4, s[8:11], s16 offen lds
    s_waitcnt lgkmcnt(0)
    v_mfma_f32_32x32x16_bf16 v[64:79], v[40:43], v[56:59], v[64:79]
    ds_read_b128 v[48:51], v11 offset:32768
    ds_read_b64_tr_b16 v[32:33], v15 offset:40960
    v_mfma_f32_32x32x16_bf16 v[80:95], v[40:43], v[60:63], v[80:95]
    ds_read_b64_tr_b16 v[34:35], v15 offset:41984
    s_add_u32 m0, s19, 67584
    s_add_u32 s16, s17, 21248
    buffer_load_dwordx4 v2, s[4:7], s16 offen lds
    v_mfma_f32_32x32x16_bf16 v[96:111], v[44:47], v[56:59], v[96:111]
    ds_read_b128 v[52:55], v11 offset:36864
    ds_read_b64_tr_b16 v[36:37], v16 offset:40960
    v_mfma_f32_32x32x16_bf16 v[112:127], v[44:47], v[60:63], v[112:127]
    ds_read_b64_tr_b16 v[38:39], v16 offset:41984
    s_add_u32 m0, s20, 67584
    s_add_u32 s16, s18, 1354752
    buffer_load_dwordx4 v4, s[8:11], s16 offen lds
    s_waitcnt lgkmcnt(0)
    v_mfma_f32_32x32x16_bf16 v[64:79], v[32:35], v[48:51], v[64:79]
    ds_read_b128 v[56:59], v12 offset:32768
    ds_read_b64_tr_b16 v[40:41], v15 offset:45056
    v_mfma_f32_32x32x16_bf16 v[80:95], v[32:35], v[52:55], v[80:95]
    ds_read_b64_tr_b16 v[42:43], v15 offset:46080
    s_add_u32 m0, s19, 68608
    s_add_u32 s16, s17, 31488
    buffer_load_dwordx4 v3, s[4:7], s16 offen lds
    v_mfma_f32_32x32x16_bf16 v[96:111], v[36:39], v[48:51], v[96:111]
    ds_read_b128 v[60:63], v12 offset:36864
    ds_read_b64_tr_b16 v[44:45], v16 offset:45056
    v_mfma_f32_32x32x16_bf16 v[112:127], v[36:39], v[52:55], v[112:127]
    ds_read_b64_tr_b16 v[46:47], v16 offset:46080
    s_add_u32 m0, s20, 68608
    s_add_u32 s16, s18, 1368576
    buffer_load_dwordx4 v4, s[8:11], s16 offen lds
    s_waitcnt lgkmcnt(0)
    s_waitcnt vmcnt(16)
    s_barrier
    v_mfma_f32_32x32x16_bf16 v[64:79], v[40:43], v[56:59], v[64:79]
    ds_read_b128 v[48:51], v5 offset:0
    ds_read_b64_tr_b16 v[32:33], v13 offset:0
    v_mfma_f32_32x32x16_bf16 v[80:95], v[40:43], v[60:63], v[80:95]
    ds_read_b64_tr_b16 v[34:35], v13 offset:1024
    s_add_u32 m0, s19, 98304
    s_add_u32 s16, s17, 896
    buffer_load_dwordx4 v2, s[4:7], s16 offen lds
    v_mfma_f32_32x32x16_bf16 v[96:111], v[44:47], v[56:59], v[96:111]
    ds_read_b128 v[52:55], v5 offset:4096
    ds_read_b64_tr_b16 v[36:37], v14 offset:0
    v_mfma_f32_32x32x16_bf16 v[112:127], v[44:47], v[60:63], v[112:127]
    ds_read_b64_tr_b16 v[38:39], v14 offset:1024
    s_add_u32 m0, s20, 98304
    s_add_u32 s16, s18, 1548288
    buffer_load_dwordx4 v4, s[8:11], s16 offen lds
    s_waitcnt lgkmcnt(0)
    v_mfma_f32_32x32x16_bf16 v[64:79], v[32:35], v[48:51], v[64:79]
    ds_read_b128 v[56:59], v6 offset:0
    ds_read_b64_tr_b16 v[40:41], v13 offset:4096
    v_mfma_f32_32x32x16_bf16 v[80:95], v[32:35], v[52:55], v[80:95]
    ds_read_b64_tr_b16 v[42:43], v13 offset:5120
    s_add_u32 m0, s19, 99328
    s_add_u32 s16, s17, 11136
    buffer_load_dwordx4 v3, s[4:7], s16 offen lds
    v_mfma_f32_32x32x16_bf16 v[96:111], v[36:39], v[48:51], v[96:111]
    ds_read_b128 v[60:63], v6 offset:4096
    ds_read_b64_tr_b16 v[44:45], v14 offset:4096
    v_mfma_f32_32x32x16_bf16 v[112:127], v[36:39], v[52:55], v[112:127]
    ds_read_b64_tr_b16 v[46:47], v14 offset:5120
    s_add_u32 m0, s20, 99328
    s_add_u32 s16, s18, 1562112
    buffer_load_dwordx4 v4, s[8:11], s16 offen lds
    s_waitcnt lgkmcnt(0)
    v_mfma_f32_32x32x16_bf16 v[64:79], v[40:43], v[56:59], v[64:79]
    ds_read_b128 v[48:51], v7 offset:0
    ds_read_b64_tr_b16 v[32:33], v13 offset:8192
    v_mfma_f32_32x32x16_bf16 v[80:95], v[40:43], v[60:63], v[80:95]
    ds_read_b64_tr_b16 v[34:35], v13 offset:9216
    s_add_u32 m0, s19, 100352
    s_add_u32 s16, s17, 21376
    buffer_load_dwordx4 v2, s[4:7], s16 offen lds
    v_mfma_f32_32x32x16_bf16 v[96:111], v[44:47], v[56:59], v[96:111]
    ds_read_b128 v[52:55], v7 offset:4096
    ds_read_b64_tr_b16 v[36:37], v14 offset:8192
    v_mfma_f32_32x32x16_bf16 v[112:127], v[44:47], v[60:63], v[112:127]
    ds_read_b64_tr_b16 v[38:39], v14 offset:9216
    s_add_u32 m0, s20, 100352
    s_add_u32 s16, s18, 1575936
    buffer_load_dwordx4 v4, s[8:11], s16 offen lds
    s_waitcnt lgkmcnt(0)
    v_mfma_f32_32x32x16_bf16 v[64:79], v[32:35], v[48:51], v[64:79]
    ds_read_b128 v[56:59], v8 offset:0
    ds_read_b64_tr_b16 v[40:41], v13 offset:12288
    v_mfma_f32_32x32x16_bf16 v[80:95], v[32:35], v[52:55], v[80:95]
    ds_read_b64_tr_b16 v[42:43], v13 offset:13312
    s_add_u32 m0, s19, 101376
    s_add_u32 s16, s17, 31616
    buffer_load_dwordx4 v3, s[4:7], s16 offen lds
    v_mfma_f32_32x32x16_bf16 v[96:111], v[36:39], v[48:51], v[96:111]
    ds_read_b128 v[60:63], v8 offset:4096
    ds_read_b64_tr_b16 v[44:45], v14 offset:12288
    v_mfma_f32_32x32x16_bf16 v[112:127], v[36:39], v[52:55], v[112:127]
    ds_read_b64_tr_b16 v[46:47], v14 offset:13312
    s_add_u32 m0, s20, 101376
    s_add_u32 s16, s18, 1589760
    buffer_load_dwordx4 v4, s[8:11], s16 offen lds
    s_waitcnt lgkmcnt(0)
    s_waitcnt vmcnt(16)
    s_barrier
    v_mfma_f32_32x32x16_bf16 v[64:79], v[40:43], v[56:59], v[64:79]
    ds_read_b128 v[48:51], v5 offset:32768
    ds_read_b64_tr_b16 v[32:33], v13 offset:32768
    v_mfma_f32_32x32x16_bf16 v[80:95], v[40:43], v[60:63], v[80:95]
    ds_read_b64_tr_b16 v[34:35], v13 offset:33792
    s_add_u32 m0, s19, 0
    s_add_u32 s16, s17, 1024
    buffer_load_dwordx4 v2, s[4:7], s16 offen lds
    v_mfma_f32_32x32x16_bf16 v[96:111], v[44:47], v[56:59], v[96:111]
    ds_read_b128 v[52:55], v5 offset:36864
    ds_read_b64_tr_b16 v[36:37], v14 offset:32768
    v_mfma_f32_32x32x16_bf16 v[112:127], v[44:47], v[60:63], v[112:127]
    ds_read_b64_tr_b16 v[38:39], v14 offset:33792
    s_add_u32 m0, s20, 0
    s_add_u32 s16, s18, 1769472
    buffer_load_dwordx4 v4, s[8:11], s16 offen lds
    s_waitcnt lgkmcnt(0)
    v_mfma_f32_32x32x16_bf16 v[64:79], v[32:35], v[48:51], v[64:79]
    ds_read_b128 v[56:59], v6 offset:32768
    ds_read_b64_tr_b16 v[40:41], v13 offset:36864
    v_mfma_f32_32x32x16_bf16 v[80:95], v[32:35], v[52:55], v[80:95]
    ds_read_b64_tr_b16 v[42:43], v13 offset:37888
    s_add_u32 m0, s19, 1024
    s_add_u32 s16, s17, 11264
    buffer_load_dwordx4 v3, s[4:7], s16 offen lds
    v_mfma_f32_32x32x16_bf16 v[96:111], v[36:39], v[48:51], v[96:111]
    ds_read_b128 v[60:63], v6 offset:36864
    ds_read_b64_tr_b16 v[44:45], v14 offset:36864
    v_mfma_f32_32x32x16_bf16 v[112:127], v[36:39], v[52:55], v[112:127]
    ds_read_b64_tr_b16 v[46:47], v14 offset:37888
    s_add_u32 m0, s20, 1024
    s_add_u32 s16, s18, 1783296
    buffer_load_dwordx4 v4, s[8:11], s16 offen lds
    s_waitcnt lgkmcnt(0)
    v_mfma_f32_32x32x16_bf16 v[64:79], v[40:43], v[56:59], v[64:79]
    ds_read_b128 v[48:51], v7 offset:32768
    ds_read_b64_tr_b16 v[32:33], v13 offset:40960
    v_mfma_f32_32x32x16_bf16 v[80:95], v[40:43], v[60:63], v[80:95]
    ds_read_b64_tr_b16 v[34:35], v13 offset:41984
    s_add_u32 m0, s19, 2048
    s_add_u32 s16, s17, 21504
    buffer_load_dwordx4 v2, s[4:7], s16 offen lds
    v_mfma_f32_32x32x16_bf16 v[96:111], v[44:47], v[56:59], v[96:111]
    ds_read_b128 v[52:55], v7 offset:36864
    ds_read_b64_tr_b16 v[36:37], v14 offset:40960
    v_mfma_f32_32x32x16_bf16 v[112:127], v[44:47], v[60:63], v[112:127]
    ds_read_b64_tr_b16 v[38:39], v14 offset:41984
    s_add_u32 m0, s20, 2048
    s_add_u32 s16, s18, 1797120
    buffer_load_dwordx4 v4, s[8:11], s16 offen lds
    s_waitcnt lgkmcnt(0)
    v_mfma_f32_32x32x16_bf16 v[64:79], v[32:35], v[48:51], v[64:79]
    ds_read_b128 v[56:59], v8 offset:32768
    ds_read_b64_tr_b16 v[40:41], v13 offset:45056
    v_mfma_f32_32x32x16_bf16 v[80:95], v[32:35], v[52:55], v[80:95]
    ds_read_b64_tr_b16 v[42:43], v13 offset:46080
    s_add_u32 m0, s19, 3072
    s_add_u32 s16, s17, 31744
    buffer_load_dwordx4 v3, s[4:7], s16 offen lds
    v_mfma_f32_32x32x16_bf16 v[96:111], v[36:39], v[48:51], v[96:111]
    ds_read_b128 v[60:63], v8 offset:36864
    ds_read_b64_tr_b16 v[44:45], v14 offset:45056
    v_mfma_f32_32x32x16_bf16 v[112:127], v[36:39], v[52:55], v[112:127]
    ds_read_b64_tr_b16 v[46:47], v14 offset:46080
    s_add_u32 m0, s20, 3072
    s_add_u32 s16, s18, 1810944
    buffer_load_dwordx4 v4, s[8:11], s16 offen lds
    s_waitcnt lgkmcnt(0)
    s_waitcnt vmcnt(16)
    s_barrier
    v_mfma_f32_32x32x16_bf16 v[64:79], v[40:43], v[56:59], v[64:79]
    ds_read_b128 v[48:51], v9 offset:0
    ds_read_b64_tr_b16 v[32:33], v15 offset:0
    v_mfma_f32_32x32x16_bf16 v[80:95], v[40:43], v[60:63], v[80:95]
    ds_read_b64_tr_b16 v[34:35], v15 offset:1024
    s_add_u32 m0, s19, 32768
    s_add_u32 s16, s17, 1152
    buffer_load_dwordx4 v2, s[4:7], s16 offen lds
    v_mfma_f32_32x32x16_bf16 v[96:111], v[44:47], v[56:59], v[96:111]
    ds_read_b128 v[52:55], v9 offset:4096
    ds_read_b64_tr_b16 v[36:37], v16 offset:0
    v_mfma_f32_32x32x16_bf16 v[112:127], v[44:47], v[60:63], v[112:127]
    ds_read_b64_tr_b16 v[38:39], v16 offset:1024
    s_add_u32 m0, s20, 32768
    s_add_u32 s16, s18, 1990656
    buffer_load_dwordx4 v4, s[8:11], s16 offen lds
    s_waitcnt lgkmcnt(0)
    v_mfma_f32_32x32x16_bf16 v[64:79], v[32:35], v[48:51], v[64:79]
    ds_read_b128 v[56:59], v10 offset:0
    ds_read_b64_tr_b16 v[40:41], v15 offset:4096
    v_mfma_f32_32x32x16_bf16 v[80:95], v[32:35], v[52:55], v[80:95]
    ds_read_b64_tr_b16 v[42:43], v15 offset:5120
    s_add_u32 m0, s19, 33792
    s_add_u32 s16, s17, 11392
    buffer_load_dwordx4 v3, s[4:7], s16 offen lds
    v_mfma_f32_32x32x16_bf16 v[96:111], v[36:39], v[48:51], v[96:111]
    ds_read_b128 v[60:63], v10 offset:4096
    ds_read_b64_tr_b16 v[44:45], v16 offset:4096
    v_mfma_f32_32x32x16_bf16 v[112:127], v[36:39], v[52:55], v[112:127]
    ds_read_b64_tr_b16 v[46:47], v16 offset:5120
    s_add_u32 m0, s20, 33792
    s_add_u32 s16, s18, 2004480
    buffer_load_dwordx4 v4, s[8:11], s16 offen lds
    s_waitcnt lgkmcnt(0)
    v_mfma_f32_32x32x16_bf16 v[64:79], v[40:43], v[56:59], v[64:79]
    ds_read_b128 v[48:51], v11 offset:0
    ds_read_b64_tr_b16 v[32:33], v15 offset:8192
    v_mfma_f32_32x32x16_bf16 v[80:95], v[40:43], v[60:63], v[80:95]
    ds_read_b64_tr_b16 v[34:35], v15 offset:9216
    s_add_u32 m0, s19, 34816
    s_add_u32 s16, s17, 21632
    buffer_load_dwordx4 v2, s[4:7], s16 offen lds
    v_mfma_f32_32x32x16_bf16 v[96:111], v[44:47], v[56:59], v[96:111]
    ds_read_b128 v[52:55], v11 offset:4096
    ds_read_b64_tr_b16 v[36:37], v16 offset:8192
    v_mfma_f32_32x32x16_bf16 v[112:127], v[44:47], v[60:63], v[112:127]
    ds_read_b64_tr_b16 v[38:39], v16 offset:9216
    s_add_u32 m0, s20, 34816
    s_add_u32 s16, s18, 2018304
    buffer_load_dwordx4 v4, s[8:11], s16 offen lds
    s_waitcnt lgkmcnt(0)
    v_mfma_f32_32x32x16_bf16 v[64:79], v[32:35], v[48:51], v[64:79]
    ds_read_b128 v[56:59], v12 offset:0
    ds_read_b64_tr_b16 v[40:41], v15 offset:12288
    v_mfma_f32_32x32x16_bf16 v[80:95], v[32:35], v[52:55], v[80:95]
    ds_read_b64_tr_b16 v[42:43], v15 offset:13312
    s_add_u32 m0, s19, 35840
    s_add_u32 s16, s17, 31872
    buffer_load_dwordx4 v3, s[4:7], s16 offen lds
    v_mfma_f32_32x32x16_bf16 v[96:111], v[36:39], v[48:51], v[96:111]
    ds_read_b128 v[60:63], v12 offset:4096
    ds_read_b64_tr_b16 v[44:45], v16 offset:12288
    v_mfma_f32_32x32x16_bf16 v[112:127], v[36:39], v[52:55], v[112:127]
    ds_read_b64_tr_b16 v[46:47], v16 offset:13312
    s_add_u32 m0, s20, 35840
    s_add_u32 s16, s18, 2032128
    buffer_load_dwordx4 v4, s[8:11], s16 offen lds
    s_waitcnt lgkmcnt(0)
    s_waitcnt vmcnt(16)
    s_barrier
    v_mfma_f32_32x32x16_bf16 v[64:79], v[40:43], v[56:59], v[64:79]
    ds_read_b128 v[48:51], v9 offset:32768
    v_mfma_f32_32x32x16_bf16 v[80:95], v[40:43], v[60:63], v[80:95]
    ds_read_b64_tr_b16 v[32:33], v15 offset:32768
    ds_read_b64_tr_b16 v[34:35], v15 offset:33792
    v_mfma_f32_32x32x16_bf16 v[96:111], v[44:47], v[56:59], v[96:111]
    ds_read_b128 v[52:55], v9 offset:36864
    v_mfma_f32_32x32x16_bf16 v[112:127], v[44:47], v[60:63], v[112:127]
    ds_read_b64_tr_b16 v[36:37], v16 offset:32768
    ds_read_b64_tr_b16 v[38:39], v16 offset:33792
    s_waitcnt lgkmcnt(0)
    v_mfma_f32_32x32x16_bf16 v[64:79], v[32:35], v[48:51], v[64:79]
    ds_read_b128 v[56:59], v10 offset:32768
    v_mfma_f32_32x32x16_bf16 v[80:95], v[32:35], v[52:55], v[80:95]
    ds_read_b64_tr_b16 v[40:41], v15 offset:36864
    ds_read_b64_tr_b16 v[42:43], v15 offset:37888
    v_mfma_f32_32x32x16_bf16 v[96:111], v[36:39], v[48:51], v[96:111]
    ds_read_b128 v[60:63], v10 offset:36864
    v_mfma_f32_32x32x16_bf16 v[112:127], v[36:39], v[52:55], v[112:127]
    ds_read_b64_tr_b16 v[44:45], v16 offset:36864
    ds_read_b64_tr_b16 v[46:47], v16 offset:37888
    s_waitcnt lgkmcnt(0)
    v_mfma_f32_32x32x16_bf16 v[64:79], v[40:43], v[56:59], v[64:79]
    ds_read_b128 v[48:51], v11 offset:32768
    v_mfma_f32_32x32x16_bf16 v[80:95], v[40:43], v[60:63], v[80:95]
    ds_read_b64_tr_b16 v[32:33], v15 offset:40960
    ds_read_b64_tr_b16 v[34:35], v15 offset:41984
    v_mfma_f32_32x32x16_bf16 v[96:111], v[44:47], v[56:59], v[96:111]
    ds_read_b128 v[52:55], v11 offset:36864
    v_mfma_f32_32x32x16_bf16 v[112:127], v[44:47], v[60:63], v[112:127]
    ds_read_b64_tr_b16 v[36:37], v16 offset:40960
    ds_read_b64_tr_b16 v[38:39], v16 offset:41984
    s_waitcnt lgkmcnt(0)
    v_mfma_f32_32x32x16_bf16 v[64:79], v[32:35], v[48:51], v[64:79]
    ds_read_b128 v[56:59], v12 offset:32768
    v_mfma_f32_32x32x16_bf16 v[80:95], v[32:35], v[52:55], v[80:95]
    ds_read_b64_tr_b16 v[40:41], v15 offset:45056
    ds_read_b64_tr_b16 v[42:43], v15 offset:46080
    v_mfma_f32_32x32x16_bf16 v[96:111], v[36:39], v[48:51], v[96:111]
    ds_read_b128 v[60:63], v12 offset:36864
    v_mfma_f32_32x32x16_bf16 v[112:127], v[36:39], v[52:55], v[112:127]
    ds_read_b64_tr_b16 v[44:45], v16 offset:45056
    ds_read_b64_tr_b16 v[46:47], v16 offset:46080
    s_waitcnt lgkmcnt(0)
    s_waitcnt vmcnt(8)
    s_barrier
    v_mfma_f32_32x32x16_bf16 v[64:79], v[40:43], v[56:59], v[64:79]
    ds_read_b128 v[48:51], v5 offset:0
    v_mfma_f32_32x32x16_bf16 v[80:95], v[40:43], v[60:63], v[80:95]
    ds_read_b64_tr_b16 v[32:33], v13 offset:0
    ds_read_b64_tr_b16 v[34:35], v13 offset:1024
    v_mfma_f32_32x32x16_bf16 v[96:111], v[44:47], v[56:59], v[96:111]
    ds_read_b128 v[52:55], v5 offset:4096
    v_mfma_f32_32x32x16_bf16 v[112:127], v[44:47], v[60:63], v[112:127]
    ds_read_b64_tr_b16 v[36:37], v14 offset:0
    ds_read_b64_tr_b16 v[38:39], v14 offset:1024
    s_waitcnt lgkmcnt(0)
    v_mfma_f32_32x32x16_bf16 v[64:79], v[32:35], v[48:51], v[64:79]
    ds_read_b128 v[56:59], v6 offset:0
    v_mfma_f32_32x32x16_bf16 v[80:95], v[32:35], v[52:55], v[80:95]
    ds_read_b64_tr_b16 v[40:41], v13 offset:4096
    ds_read_b64_tr_b16 v[42:43], v13 offset:5120
    v_mfma_f32_32x32x16_bf16 v[96:111], v[36:39], v[48:51], v[96:111]
    ds_read_b128 v[60:63], v6 offset:4096
    v_mfma_f32_32x32x16_bf16 v[112:127], v[36:39], v[52:55], v[112:127]
    ds_read_b64_tr_b16 v[44:45], v14 offset:4096
    ds_read_b64_tr_b16 v[46:47], v14 offset:5120
    s_waitcnt lgkmcnt(0)
    v_mfma_f32_32x32x16_bf16 v[64:79], v[40:43], v[56:59], v[64:79]
    ds_read_b128 v[48:51], v7 offset:0
    v_mfma_f32_32x32x16_bf16 v[80:95], v[40:43], v[60:63], v[80:95]
    ds_read_b64_tr_b16 v[32:33], v13 offset:8192
    ds_read_b64_tr_b16 v[34:35], v13 offset:9216
    v_mfma_f32_32x32x16_bf16 v[96:111], v[44:47], v[56:59], v[96:111]
    ds_read_b128 v[52:55], v7 offset:4096
    v_mfma_f32_32x32x16_bf16 v[112:127], v[44:47], v[60:63], v[112:127]
    ds_read_b64_tr_b16 v[36:37], v14 offset:8192
    ds_read_b64_tr_b16 v[38:39], v14 offset:9216
    s_waitcnt lgkmcnt(0)
    v_mfma_f32_32x32x16_bf16 v[64:79], v[32:35], v[48:51], v[64:79]
    ds_read_b128 v[56:59], v8 offset:0
    v_mfma_f32_32x32x16_bf16 v[80:95], v[32:35], v[52:55], v[80:95]
    ds_read_b64_tr_b16 v[40:41], v13 offset:12288
    ds_read_b64_tr_b16 v[42:43], v13 offset:13312
    v_mfma_f32_32x32x16_bf16 v[96:111], v[36:39], v[48:51], v[96:111]
    ds_read_b128 v[60:63], v8 offset:4096
    v_mfma_f32_32x32x16_bf16 v[112:127], v[36:39], v[52:55], v[112:127]
    ds_read_b64_tr_b16 v[44:45], v14 offset:12288
    ds_read_b64_tr_b16 v[46:47], v14 offset:13312
    s_waitcnt lgkmcnt(0)
    s_waitcnt vmcnt(0)
    s_barrier
    v_mfma_f32_32x32x16_bf16 v[64:79], v[40:43], v[56:59], v[64:79]
    ds_read_b128 v[48:51], v5 offset:32768
    v_mfma_f32_32x32x16_bf16 v[80:95], v[40:43], v[60:63], v[80:95]
    ds_read_b64_tr_b16 v[32:33], v13 offset:32768
    ds_read_b64_tr_b16 v[34:35], v13 offset:33792
    v_mfma_f32_32x32x16_bf16 v[96:111], v[44:47], v[56:59], v[96:111]
    ds_read_b128 v[52:55], v5 offset:36864
    v_mfma_f32_32x32x16_bf16 v[112:127], v[44:47], v[60:63], v[112:127]
    ds_read_b64_tr_b16 v[36:37], v14 offset:32768
    ds_read_b64_tr_b16 v[38:39], v14 offset:33792
    s_waitcnt lgkmcnt(0)
    v_mfma_f32_32x32x16_bf16 v[64:79], v[32:35], v[48:51], v[64:79]
    ds_read_b128 v[56:59], v6 offset:32768
    v_mfma_f32_32x32x16_bf16 v[80:95], v[32:35], v[52:55], v[80:95]
    ds_read_b64_tr_b16 v[40:41], v13 offset:36864
    ds_read_b64_tr_b16 v[42:43], v13 offset:37888
    v_mfma_f32_32x32x16_bf16 v[96:111], v[36:39], v[48:51], v[96:111]
    ds_read_b128 v[60:63], v6 offset:36864
    v_mfma_f32_32x32x16_bf16 v[112:127], v[36:39], v[52:55], v[112:127]
    ds_read_b64_tr_b16 v[44:45], v14 offset:36864
    ds_read_b64_tr_b16 v[46:47], v14 offset:37888
    s_waitcnt lgkmcnt(0)
    v_mfma_f32_32x32x16_bf16 v[64:79], v[40:43], v[56:59], v[64:79]
    ds_read_b128 v[48:51], v7 offset:32768
    v_mfma_f32_32x32x16_bf16 v[80:95], v[40:43], v[60:63], v[80:95]
    ds_read_b64_tr_b16 v[32:33], v13 offset:40960
    ds_read_b64_tr_b16 v[34:35], v13 offset:41984
    v_mfma_f32_32x32x16_bf16 v[96:111], v[44:47], v[56:59], v[96:111]
    ds_read_b128 v[52:55], v7 offset:36864
    v_mfma_f32_32x32x16_bf16 v[112:127], v[44:47], v[60:63], v[112:127]
    ds_read_b64_tr_b16 v[36:37], v14 offset:40960
    ds_read_b64_tr_b16 v[38:39], v14 offset:41984
    s_waitcnt lgkmcnt(0)
    v_mfma_f32_32x32x16_bf16 v[64:79], v[32:35], v[48:51], v[64:79]
    ds_read_b128 v[56:59], v8 offset:32768
    v_mfma_f32_32x32x16_bf16 v[80:95], v[32:35], v[52:55], v[80:95]
    ds_read_b64_tr_b16 v[40:41], v13 offset:45056
    ds_read_b64_tr_b16 v[42:43], v13 offset:46080
    v_mfma_f32_32x32x16_bf16 v[96:111], v[36:39], v[48:51], v[96:111]
    ds_read_b128 v[60:63], v8 offset:36864
    v_mfma_f32_32x32x16_bf16 v[112:127], v[36:39], v[52:55], v[112:127]
    ds_read_b64_tr_b16 v[44:45], v14 offset:45056
    ds_read_b64_tr_b16 v[46:47], v14 offset:46080
    s_waitcnt lgkmcnt(0)
    v_mfma_f32_32x32x16_bf16 v[64:79], v[40:43], v[56:59], v[64:79]
    v_mfma_f32_32x32x16_bf16 v[80:95], v[40:43], v[60:63], v[80:95]
    v_mfma_f32_32x32x16_bf16 v[96:111], v[44:47], v[56:59], v[96:111]
    v_mfma_f32_32x32x16_bf16 v[112:127], v[44:47], v[60:63], v[112:127]
    s_lshl_b32 s24, s35, 6
    s_add_u32 s24, s24, s23
    s_cmp_ge_u32 s24, 1728
    s_cbranch_scc1 G1_END
    v_lshrrev_b32 v18, 4, v1
    v_and_b32 v18, 1, v18
    s_lshl_b32 s24, s34, 2
    v_add_u32 v18, s24, v18
    v_mul_u32_u24 v18, 55296, v18
    v_lshrrev_b32 v19, 5, v1
    v_lshlrev_b32 v19, 4, v19
    v_and_b32 v20, 15, v1
    v_add_u32 v19, v19, v20
    v_lshlrev_b32 v19, 4, v19
    v_add_u32 v2, v18, v19
    v_add_u32 v3, 110592, v2
    s_lshr_b32 s16, s22, 4
    s_mul_i32 s16, s16, 54
    s_lshl_b32 s24, s35, 6
    s_add_u32 s24, s24, s23
    s_lshr_b32 s24, s24, 5
    s_add_u32 s16, s16, s24
    s_lshl_b32 s16, s16, 10
    s_mov_b32 s36, 0xbfb8aa3b
    s_mov_b32 s37, 0xbfb8aa3b
    s_mov_b32 s38, 0xffff0000
    s_nop 15
    v_cvt_pk_bf16_f32 v48, v64, v65
    v_cvt_pk_bf16_f32 v49, v66, v67
    v_cvt_pk_bf16_f32 v50, v68, v69
    v_cvt_pk_bf16_f32 v51, v70, v71
    v_lshlrev_b32 v32, 16, v48
    v_and_b32 v33, s38, v48
    v_lshlrev_b32 v34, 16, v49
    v_and_b32 v35, s38, v49
    v_lshlrev_b32 v36, 16, v50
    v_and_b32 v37, s38, v50
    v_lshlrev_b32 v38, 16, v51
    v_and_b32 v39, s38, v51
    v_pk_mul_f32 v[40:41], v[32:33], s[36:37]
    v_pk_mul_f32 v[42:43], v[34:35], s[36:37]
    v_pk_mul_f32 v[44:45], v[36:37], s[36:37]
    v_pk_mul_f32 v[46:47], v[38:39], s[36:37]
    v_exp_f32 v40, v40
    v_exp_f32 v41, v41
    v_exp_f32 v42, v42
    v_exp_f32 v43, v43
    v_exp_f32 v44, v44
    v_exp_f32 v45, v45
    v_exp_f32 v46, v46
    v_exp_f32 v47, v47
    v_pk_add_f32 v[40:41], v[40:41], 1.0 op_sel_hi:[1,0]
    v_pk_add_f32 v[42:43], v[42:43], 1.0 op_sel_hi:[1,0]
    v_pk_add_f32 v[44:45], v[44:45], 1.0 op_sel_hi:[1,0]
    v_pk_add_f32 v[46:47], v[46:47], 1.0 op_sel_hi:[1,0]
    v_rcp_f32 v40, v40
    v_rcp_f32 v41, v41
    v_rcp_f32 v42, v42
    v_rcp_f32 v43, v43
    v_rcp_f32 v44, v44
    v_rcp_f32 v45, v45
    v_rcp_f32 v46, v46
    v_rcp_f32 v47, v47
    v_pk_mul_f32 v[32:33], v[32:33], v[40:41]
    v_pk_mul_f32 v[34:35], v[34:35], v[42:43]
    v_pk_mul_f32 v[36:37], v[36:37], v[44:45]
    v_pk_mul_f32 v[38:39], v[38:39], v[46:47]
    v_cvt_pk_bf16_f32 v52, v32, v33
    v_cvt_pk_bf16_f32 v53, v34, v35
    v_cvt_pk_bf16_f32 v54, v36, v37
    v_cvt_pk_bf16_f32 v55, v38, v39
    s_nop 1
    v_permlane32_swap_b32 v52, v54
    v_permlane32_swap_b32 v53, v55
    buffer_store_dwordx4 v[52:55], v2, s[12:15], s16 offen offset:0
    v_cvt_pk_bf16_f32 v48, v72, v73
    v_cvt_pk_bf16_f32 v49, v74, v75
    v_cvt_pk_bf16_f32 v50, v76, v77
    v_cvt_pk_bf16_f32 v51, v78, v79
    v_lshlrev_b32 v32, 16, v48
    v_and_b32 v33, s38, v48
    v_lshlrev_b32 v34, 16, v49
    v_and_b32 v35, s38, v49
    v_lshlrev_b32 v36, 16, v50
    v_and_b32 v37, s38, v50
    v_lshlrev_b32 v38, 16, v51
    v_and_b32 v39, s38, v51
    v_pk_mul_f32 v[40:41], v[32:33], s[36:37]
    v_pk_mul_f32 v[42:43], v[34:35], s[36:37]
    v_pk_mul_f32 v[44:45], v[36:37], s[36:37]
    v_pk_mul_f32 v[46:47], v[38:39], s[36:37]
    v_exp_f32 v40, v40
    v_exp_f32 v41, v41
    v_exp_f32 v42, v42
    v_exp_f32 v43, v43
    v_exp_f32 v44, v44
    v_exp_f32 v45, v45
    v_exp_f32 v46, v46
    v_exp_f32 v47, v47
    v_pk_add_f32 v[40:41], v[40:41], 1.0 op_sel_hi:[1,0]
    v_pk_add_f32 v[42:43], v[42:43], 1.0 op_sel_hi:[1,0]
    v_pk_add_f32 v[44:45], v[44:45], 1.0 op_sel_hi:[1,0]
    v_pk_add_f32 v[46:47], v[46:47], 1.0 op_sel_hi:[1,0]
    v_rcp_f32 v40, v40
    v_rcp_f32 v41, v41
    v_rcp_f32 v42, v42
    v_rcp_f32 v43, v43
    v_rcp_f32 v44, v44
    v_rcp_f32 v45, v45
    v_rcp_f32 v46, v46
    v_rcp_f32 v47, v47
    v_pk_mul_f32 v[32:33], v[32:33], v[40:41]
    v_pk_mul_f32 v[34:35], v[34:35], v[42:43]
    v_pk_mul_f32 v[36:37], v[36:37], v[44:45]
    v_pk_mul_f32 v[38:39], v[38:39], v[46:47]
    v_cvt_pk_bf16_f32 v56, v32, v33
    v_cvt_pk_bf16_f32 v57, v34, v35
    v_cvt_pk_bf16_f32 v58, v36, v37
    v_cvt_pk_bf16_f32 v59, v38, v39
    s_nop 1
    v_permlane32_swap_b32 v56, v58
    v_permlane32_swap_b32 v57, v59
    buffer_store_dwordx4 v[56:59], v2, s[12:15], s16 offen offset:512
    v_cvt_pk_bf16_f32 v48, v80, v81
    v_cvt_pk_bf16_f32 v49, v82, v83
    v_cvt_pk_bf16_f32 v50, v84, v85
    v_cvt_pk_bf16_f32 v51, v86, v87
    v_lshlrev_b32 v32, 16, v48
    v_and_b32 v33, s38, v48
    v_lshlrev_b32 v34, 16, v49
    v_and_b32 v35, s38, v49
    v_lshlrev_b32 v36, 16, v50
    v_and_b32 v37, s38, v50
    v_lshlrev_b32 v38, 16, v51
    v_and_b32 v39, s38, v51
    v_pk_mul_f32 v[40:41], v[32:33], s[36:37]
    v_pk_mul_f32 v[42:43], v[34:35], s[36:37]
    v_pk_mul_f32 v[44:45], v[36:37], s[36:37]
    v_pk_mul_f32 v[46:47], v[38:39], s[36:37]
    v_exp_f32 v40, v40
    v_exp_f32 v41, v41
    v_exp_f32 v42, v42
    v_exp_f32 v43, v43
    v_exp_f32 v44, v44
    v_exp_f32 v45, v45
    v_exp_f32 v46, v46
    v_exp_f32 v47, v47
    v_pk_add_f32 v[40:41], v[40:41], 1.0 op_sel_hi:[1,0]
    v_pk_add_f32 v[42:43], v[42:43], 1.0 op_sel_hi:[1,0]
    v_pk_add_f32 v[44:45], v[44:45], 1.0 op_sel_hi:[1,0]
    v_pk_add_f32 v[46:47], v[46:47], 1.0 op_sel_hi:[1,0]
    v_rcp_f32 v40, v40
    v_rcp_f32 v41, v41
    v_rcp_f32 v42, v42
    v_rcp_f32 v43, v43
    v_rcp_f32 v44, v44
    v_rcp_f32 v45, v45
    v_rcp_f32 v46, v46
    v_rcp_f32 v47, v47
    v_pk_mul_f32 v[32:33], v[32:33], v[40:41]
    v_pk_mul_f32 v[34:35], v[34:35], v[42:43]
    v_pk_mul_f32 v[36:37], v[36:37], v[44:45]
    v_pk_mul_f32 v[38:39], v[38:39], v[46:47]
    v_cvt_pk_bf16_f32 v52, v32, v33
    v_cvt_pk_bf16_f32 v53, v34, v35
    v_cvt_pk_bf16_f32 v54, v36, v37
    v_cvt_pk_bf16_f32 v55, v38, v39
    s_nop 1
    v_permlane32_swap_b32 v52, v54
    v_permlane32_swap_b32 v53, v55
    buffer_store_dwordx4 v[52:55], v3, s[12:15], s16 offen offset:0
    v_cvt_pk_bf16_f32 v48, v88, v89
    v_cvt_pk_bf16_f32 v49, v90, v91
    v_cvt_pk_bf16_f32 v50, v92, v93
    v_cvt_pk_bf16_f32 v51, v94, v95
    v_lshlrev_b32 v32, 16, v48
    v_and_b32 v33, s38, v48
    v_lshlrev_b32 v34, 16, v49
    v_and_b32 v35, s38, v49
    v_lshlrev_b32 v36, 16, v50
    v_and_b32 v37, s38, v50
    v_lshlrev_b32 v38, 16, v51
    v_and_b32 v39, s38, v51
    v_pk_mul_f32 v[40:41], v[32:33], s[36:37]
    v_pk_mul_f32 v[42:43], v[34:35], s[36:37]
    v_pk_mul_f32 v[44:45], v[36:37], s[36:37]
    v_pk_mul_f32 v[46:47], v[38:39], s[36:37]
    v_exp_f32 v40, v40
    v_exp_f32 v41, v41
    v_exp_f32 v42, v42
    v_exp_f32 v43, v43
    v_exp_f32 v44, v44
    v_exp_f32 v45, v45
    v_exp_f32 v46, v46
    v_exp_f32 v47, v47
    v_pk_add_f32 v[40:41], v[40:41], 1.0 op_sel_hi:[1,0]
    v_pk_add_f32 v[42:43], v[42:43], 1.0 op_sel_hi:[1,0]
    v_pk_add_f32 v[44:45], v[44:45], 1.0 op_sel_hi:[1,0]
    v_pk_add_f32 v[46:47], v[46:47], 1.0 op_sel_hi:[1,0]
    v_rcp_f32 v40, v40
    v_rcp_f32 v41, v41
    v_rcp_f32 v42, v42
    v_rcp_f32 v43, v43
    v_rcp_f32 v44, v44
    v_rcp_f32 v45, v45
    v_rcp_f32 v46, v46
    v_rcp_f32 v47, v47
    v_pk_mul_f32 v[32:33], v[32:33], v[40:41]
    v_pk_mul_f32 v[34:35], v[34:35], v[42:43]
    v_pk_mul_f32 v[36:37], v[36:37], v[44:45]
    v_pk_mul_f32 v[38:39], v[38:39], v[46:47]
    v_cvt_pk_bf16_f32 v56, v32, v33
    v_cvt_pk_bf16_f32 v57, v34, v35
    v_cvt_pk_bf16_f32 v58, v36, v37
    v_cvt_pk_bf16_f32 v59, v38, v39
    s_nop 1
    v_permlane32_swap_b32 v56, v58
    v_permlane32_swap_b32 v57, v59
    buffer_store_dwordx4 v[56:59], v3, s[12:15], s16 offen offset:512
    v_cvt_pk_bf16_f32 v48, v96, v97
    v_cvt_pk_bf16_f32 v49, v98, v99
    v_cvt_pk_bf16_f32 v50, v100, v101
    v_cvt_pk_bf16_f32 v51, v102, v103
    v_lshlrev_b32 v32, 16, v48
    v_and_b32 v33, s38, v48
    v_lshlrev_b32 v34, 16, v49
    v_and_b32 v35, s38, v49
    v_lshlrev_b32 v36, 16, v50
    v_and_b32 v37, s38, v50
    v_lshlrev_b32 v38, 16, v51
    v_and_b32 v39, s38, v51
    v_pk_mul_f32 v[40:41], v[32:33], s[36:37]
    v_pk_mul_f32 v[42:43], v[34:35], s[36:37]
    v_pk_mul_f32 v[44:45], v[36:37], s[36:37]
    v_pk_mul_f32 v[46:47], v[38:39], s[36:37]
    v_exp_f32 v40, v40
    v_exp_f32 v41, v41
    v_exp_f32 v42, v42
    v_exp_f32 v43, v43
    v_exp_f32 v44, v44
    v_exp_f32 v45, v45
    v_exp_f32 v46, v46
    v_exp_f32 v47, v47
    v_pk_add_f32 v[40:41], v[40:41], 1.0 op_sel_hi:[1,0]
    v_pk_add_f32 v[42:43], v[42:43], 1.0 op_sel_hi:[1,0]
    v_pk_add_f32 v[44:45], v[44:45], 1.0 op_sel_hi:[1,0]
    v_pk_add_f32 v[46:47], v[46:47], 1.0 op_sel_hi:[1,0]
    v_rcp_f32 v40, v40
    v_rcp_f32 v41, v41
    v_rcp_f32 v42, v42
    v_rcp_f32 v43, v43
    v_rcp_f32 v44, v44
    v_rcp_f32 v45, v45
    v_rcp_f32 v46, v46
    v_rcp_f32 v47, v47
    v_pk_mul_f32 v[32:33], v[32:33], v[40:41]
    v_pk_mul_f32 v[34:35], v[34:35], v[42:43]
    v_pk_mul_f32 v[36:37], v[36:37], v[44:45]
    v_pk_mul_f32 v[38:39], v[38:39], v[46:47]
    v_cvt_pk_bf16_f32 v52, v32, v33
    v_cvt_pk_bf16_f32 v53, v34, v35
    v_cvt_pk_bf16_f32 v54, v36, v37
    v_cvt_pk_bf16_f32 v55, v38, v39
    s_nop 1
    v_permlane32_swap_b32 v52, v54
    v_permlane32_swap_b32 v53, v55
    buffer_store_dwordx4 v[52:55], v2, s[12:15], s16 offen offset:1024
    v_cvt_pk_bf16_f32 v48, v104, v105
    v_cvt_pk_bf16_f32 v49, v106, v107
    v_cvt_pk_bf16_f32 v50, v108, v109
    v_cvt_pk_bf16_f32 v51, v110, v111
    v_lshlrev_b32 v32, 16, v48
    v_and_b32 v33, s38, v48
    v_lshlrev_b32 v34, 16, v49
    v_and_b32 v35, s38, v49
    v_lshlrev_b32 v36, 16, v50
    v_and_b32 v37, s38, v50
    v_lshlrev_b32 v38, 16, v51
    v_and_b32 v39, s38, v51
    v_pk_mul_f32 v[40:41], v[32:33], s[36:37]
    v_pk_mul_f32 v[42:43], v[34:35], s[36:37]
    v_pk_mul_f32 v[44:45], v[36:37], s[36:37]
    v_pk_mul_f32 v[46:47], v[38:39], s[36:37]
    v_exp_f32 v40, v40
    v_exp_f32 v41, v41
    v_exp_f32 v42, v42
    v_exp_f32 v43, v43
    v_exp_f32 v44, v44
    v_exp_f32 v45, v45
    v_exp_f32 v46, v46
    v_exp_f32 v47, v47
    v_pk_add_f32 v[40:41], v[40:41], 1.0 op_sel_hi:[1,0]
    v_pk_add_f32 v[42:43], v[42:43], 1.0 op_sel_hi:[1,0]
    v_pk_add_f32 v[44:45], v[44:45], 1.0 op_sel_hi:[1,0]
    v_pk_add_f32 v[46:47], v[46:47], 1.0 op_sel_hi:[1,0]
    v_rcp_f32 v40, v40
    v_rcp_f32 v41, v41
    v_rcp_f32 v42, v42
    v_rcp_f32 v43, v43
    v_rcp_f32 v44, v44
    v_rcp_f32 v45, v45
    v_rcp_f32 v46, v46
    v_rcp_f32 v47, v47
    v_pk_mul_f32 v[32:33], v[32:33], v[40:41]
    v_pk_mul_f32 v[34:35], v[34:35], v[42:43]
    v_pk_mul_f32 v[36:37], v[36:37], v[44:45]
    v_pk_mul_f32 v[38:39], v[38:39], v[46:47]
    v_cvt_pk_bf16_f32 v56, v32, v33
    v_cvt_pk_bf16_f32 v57, v34, v35
    v_cvt_pk_bf16_f32 v58, v36, v37
    v_cvt_pk_bf16_f32 v59, v38, v39
    s_nop 1
    v_permlane32_swap_b32 v56, v58
    v_permlane32_swap_b32 v57, v59
    buffer_store_dwordx4 v[56:59], v2, s[12:15], s16 offen offset:1536
    v_cvt_pk_bf16_f32 v48, v112, v113
    v_cvt_pk_bf16_f32 v49, v114, v115
    v_cvt_pk_bf16_f32 v50, v116, v117
    v_cvt_pk_bf16_f32 v51, v118, v119
    v_lshlrev_b32 v32, 16, v48
    v_and_b32 v33, s38, v48
    v_lshlrev_b32 v34, 16, v49
    v_and_b32 v35, s38, v49
    v_lshlrev_b32 v36, 16, v50
    v_and_b32 v37, s38, v50
    v_lshlrev_b32 v38, 16, v51
    v_and_b32 v39, s38, v51
    v_pk_mul_f32 v[40:41], v[32:33], s[36:37]
    v_pk_mul_f32 v[42:43], v[34:35], s[36:37]
    v_pk_mul_f32 v[44:45], v[36:37], s[36:37]
    v_pk_mul_f32 v[46:47], v[38:39], s[36:37]
    v_exp_f32 v40, v40
    v_exp_f32 v41, v41
    v_exp_f32 v42, v42
    v_exp_f32 v43, v43
    v_exp_f32 v44, v44
    v_exp_f32 v45, v45
    v_exp_f32 v46, v46
    v_exp_f32 v47, v47
    v_pk_add_f32 v[40:41], v[40:41], 1.0 op_sel_hi:[1,0]
    v_pk_add_f32 v[42:43], v[42:43], 1.0 op_sel_hi:[1,0]
    v_pk_add_f32 v[44:45], v[44:45], 1.0 op_sel_hi:[1,0]
    v_pk_add_f32 v[46:47], v[46:47], 1.0 op_sel_hi:[1,0]
    v_rcp_f32 v40, v40
    v_rcp_f32 v41, v41
    v_rcp_f32 v42, v42
    v_rcp_f32 v43, v43
    v_rcp_f32 v44, v44
    v_rcp_f32 v45, v45
    v_rcp_f32 v46, v46
    v_rcp_f32 v47, v47
    v_pk_mul_f32 v[32:33], v[32:33], v[40:41]
    v_pk_mul_f32 v[34:35], v[34:35], v[42:43]
    v_pk_mul_f32 v[36:37], v[36:37], v[44:45]
    v_pk_mul_f32 v[38:39], v[38:39], v[46:47]
    v_cvt_pk_bf16_f32 v52, v32, v33
    v_cvt_pk_bf16_f32 v53, v34, v35
    v_cvt_pk_bf16_f32 v54, v36, v37
    v_cvt_pk_bf16_f32 v55, v38, v39
    s_nop 1
    v_permlane32_swap_b32 v52, v54
    v_permlane32_swap_b32 v53, v55
    buffer_store_dwordx4 v[52:55], v3, s[12:15], s16 offen offset:1024
    v_cvt_pk_bf16_f32 v48, v120, v121
    v_cvt_pk_bf16_f32 v49, v122, v123
    v_cvt_pk_bf16_f32 v50, v124, v125
    v_cvt_pk_bf16_f32 v51, v126, v127
    v_lshlrev_b32 v32, 16, v48
    v_and_b32 v33, s38, v48
    v_lshlrev_b32 v34, 16, v49
    v_and_b32 v35, s38, v49
    v_lshlrev_b32 v36, 16, v50
    v_and_b32 v37, s38, v50
    v_lshlrev_b32 v38, 16, v51
    v_and_b32 v39, s38, v51
    v_pk_mul_f32 v[40:41], v[32:33], s[36:37]
    v_pk_mul_f32 v[42:43], v[34:35], s[36:37]
    v_pk_mul_f32 v[44:45], v[36:37], s[36:37]
    v_pk_mul_f32 v[46:47], v[38:39], s[36:37]
    v_exp_f32 v40, v40
    v_exp_f32 v41, v41
    v_exp_f32 v42, v42
    v_exp_f32 v43, v43
    v_exp_f32 v44, v44
    v_exp_f32 v45, v45
    v_exp_f32 v46, v46
    v_exp_f32 v47, v47
    v_pk_add_f32 v[40:41], v[40:41], 1.0 op_sel_hi:[1,0]
    v_pk_add_f32 v[42:43], v[42:43], 1.0 op_sel_hi:[1,0]
    v_pk_add_f32 v[44:45], v[44:45], 1.0 op_sel_hi:[1,0]
    v_pk_add_f32 v[46:47], v[46:47], 1.0 op_sel_hi:[1,0]
    v_rcp_f32 v40, v40
    v_rcp_f32 v41, v41
    v_rcp_f32 v42, v42
    v_rcp_f32 v43, v43
    v_rcp_f32 v44, v44
    v_rcp_f32 v45, v45
    v_rcp_f32 v46, v46
    v_rcp_f32 v47, v47
    v_pk_mul_f32 v[32:33], v[32:33], v[40:41]
    v_pk_mul_f32 v[34:35], v[34:35], v[42:43]
    v_pk_mul_f32 v[36:37], v[36:37], v[44:45]
    v_pk_mul_f32 v[38:39], v[38:39], v[46:47]
    v_cvt_pk_bf16_f32 v56, v32, v33
    v_cvt_pk_bf16_f32 v57, v34, v35
    v_cvt_pk_bf16_f32 v58, v36, v37
    v_cvt_pk_bf16_f32 v59, v38, v39
    s_nop 1
    v_permlane32_swap_b32 v56, v58
    v_permlane32_swap_b32 v57, v59
    buffer_store_dwordx4 v[56:59], v3, s[12:15], s16 offen offset:1536
    s_waitcnt vmcnt(0)
    s_endpgm
G1_REPACK:
    s_load_dwordx2 s[36:37], s[0:1], 16
    v_lshrrev_b32 v1, 6, v0
    v_and_b32 v12, 63, v0
    v_readfirstlane_b32 s21, v1
    v_mov_b32 v1, v12
    v_add_u32 v12, 0, v1
    v_mul_u32_u24 v13, 205, v12
    v_lshrrev_b32 v13, 11, v13
    v_mul_u32_u24 v14, 10, v13
    v_sub_u32 v14, v12, v14
    v_and_b32 v15, 0x33, v13
    v_and_b32 v12, 4, v13
    v_lshlrev_b32 v12, 1, v12
    v_or_b32 v15, v15, v12
    v_and_b32 v12, 8, v13
    v_lshrrev_b32 v12, 1, v12
    v_or_b32 v15, v15, v12
    v_mul_u32_u24 v15, 0x500, v15
    v_lshlrev_b32 v14, 4, v14
    v_add_u32 v2, v15, v14
    v_add_u32 v12, 64, v1
    v_mul_u32_u24 v13, 205, v12
    v_lshrrev_b32 v13, 11, v13
    v_mul_u32_u24 v14, 10, v13
    v_sub_u32 v14, v12, v14
    v_and_b32 v15, 0x33, v13
    v_and_b32 v12, 4, v13
    v_lshlrev_b32 v12, 1, v12
    v_or_b32 v15, v15, v12
    v_and_b32 v12, 8, v13
    v_lshrrev_b32 v12, 1, v12
    v_or_b32 v15, v15, v12
    v_mul_u32_u24 v15, 0x500, v15
    v_lshlrev_b32 v14, 4, v14
    v_add_u32 v3, v15, v14
    v_add_u32 v12, 128, v1
    v_mul_u32_u24 v13, 205, v12
    v_lshrrev_b32 v13, 11, v13
    v_mul_u32_u24 v14, 10, v13
    v_sub_u32 v14, v12, v14
    v_and_b32 v15, 0x33, v13
    v_and_b32 v12, 4, v13
    v_lshlrev_b32 v12, 1, v12
    v_or_b32 v15, v15, v12
    v_and_b32 v12, 8, v13
    v_lshrrev_b32 v12, 1, v12
    v_or_b32 v15, v15, v12
    v_mul_u32_u24 v15, 0x500, v15
    v_lshlrev_b32 v14, 4, v14
    v_add_u32 v4, v15, v14
    v_add_u32 v12, 192, v1
    v_mul_u32_u24 v13, 205, v12
    v_lshrrev_b32 v13, 11, v13
    v_mul_u32_u24 v14, 10, v13
    v_sub_u32 v14, v12, v14
    v_and_b32 v15, 0x33, v13
    v_and_b32 v12, 4, v13
    v_lshlrev_b32 v12, 1, v12
    v_or_b32 v15, v15, v12
    v_and_b32 v12, 8, v13
    v_lshrrev_b32 v12, 1, v12
    v_or_b32 v15, v15, v12
    v_mul_u32_u24 v15, 0x500, v15
    v_lshlrev_b32 v14, 4, v14
    v_add_u32 v5, v15, v14
    v_add_u32 v12, 256, v1
    v_mul_u32_u24 v13, 205, v12
    v_lshrrev_b32 v13, 11, v13
    v_mul_u32_u24 v14, 10, v13
    v_sub_u32 v14, v12, v14
    v_and_b32 v15, 0x33, v13
    v_and_b32 v12, 4, v13
    v_lshlrev_b32 v12, 1, v12
    v_or_b32 v15, v15, v12
    v_and_b32 v12, 8, v13
    v_lshrrev_b32 v12, 1, v12
    v_or_b32 v15, v15, v12
    v_mul_u32_u24 v15, 0x500, v15
    v_lshlrev_b32 v14, 4, v14
    v_add_u32 v6, v15, v14
    v_lshlrev_b32 v7, 4, v1
    s_sub_u32 s22, s2, 224
    s_lshl_b32 s22, s22, 2
    s_add_u32 s22, s22, s21
    s_waitcnt lgkmcnt(0)
    s_mov_b32 s8, s36
    s_and_b32 s9, s37, 0xffff
    s_mov_b32 s10, 2211840
    s_mov_b32 s11, 0x00020000
    s_mov_b32 s12, s32
    s_and_b32 s13, s33, 0xffff
    s_mov_b32 s14, 10600448
    s_mov_b32 s15, 0x00020000
    s_nop 4
    s_add_u32 s23, s22, 0
    s_lshr_b32 s24, s23, 1
    s_mul_i32 s25, s24, 1214
    s_lshr_b32 s25, s25, 15
    s_mul_i32 s26, s25, 27
    s_sub_u32 s26, s24, s26
    s_and_b32 s27, s23, 1
    s_lshl_b32 s26, s26, 1
    s_add_u32 s26, s26, s27
    s_mul_i32 s26, s26, 40960
    s_mul_i32 s25, s25, 160
    s_add_u32 s40, s26, s25
    s_mul_i32 s27, s23, 5120
    s_add_u32 s48, s27, 8388608
    s_add_u32 s49, s48, 4096
    buffer_load_dwordx4 v[16:19], v2, s[8:11], s40 offen
    buffer_load_dwordx4 v[20:23], v3, s[8:11], s40 offen
    buffer_load_dwordx4 v[24:27], v4, s[8:11], s40 offen
    buffer_load_dwordx4 v[28:31], v5, s[8:11], s40 offen
    buffer_load_dwordx4 v[32:35], v6, s[8:11], s40 offen
    s_add_u32 s23, s22, 128
    s_lshr_b32 s24, s23, 1
    s_mul_i32 s25, s24, 1214
    s_lshr_b32 s25, s25, 15
    s_mul_i32 s26, s25, 27
    s_sub_u32 s26, s24, s26
    s_and_b32 s27, s23, 1
    s_lshl_b32 s26, s26, 1
    s_add_u32 s26, s26, s27
    s_mul_i32 s26, s26, 40960
    s_mul_i32 s25, s25, 160
    s_add_u32 s41, s26, s25
    s_mul_i32 s27, s23, 5120
    s_add_u32 s50, s27, 8388608
    s_add_u32 s51, s50, 4096
    buffer_load_dwordx4 v[36:39], v2, s[8:11], s41 offen
    buffer_load_dwordx4 v[40:43], v3, s[8:11], s41 offen
    buffer_load_dwordx4 v[44:47], v4, s[8:11], s41 offen
    buffer_load_dwordx4 v[48:51], v5, s[8:11], s41 offen
    buffer_load_dwordx4 v[52:55], v6, s[8:11], s41 offen
    s_add_u32 s23, s22, 256
    s_lshr_b32 s24, s23, 1
    s_mul_i32 s25, s24, 1214
    s_lshr_b32 s25, s25, 15
    s_mul_i32 s26, s25, 27
    s_sub_u32 s26, s24, s26
    s_and_b32 s27, s23, 1
    s_lshl_b32 s26, s26, 1
    s_add_u32 s26, s26, s27
    s_mul_i32 s26, s26, 40960
    s_mul_i32 s25, s25, 160
    s_add_u32 s42, s26, s25
    s_mul_i32 s27, s23, 5120
    s_add_u32 s52, s27, 8388608
    s_add_u32 s53, s52, 4096
    buffer_load_dwordx4 v[56:59], v2, s[8:11], s42 offen
    buffer_load_dwordx4 v[60:63], v3, s[8:11], s42 offen
    buffer_load_dwordx4 v[64:67], v4, s[8:11], s42 offen
    buffer_load_dwordx4 v[68:71], v5, s[8:11], s42 offen
    buffer_load_dwordx4 v[72:75], v6, s[8:11], s42 offen
    s_cmp_ge_u32 s22, 48
    s_cbranch_scc1 G1_RP3
    s_add_u32 s23, s22, 384
    s_lshr_b32 s24, s23, 1
    s_mul_i32 s25, s24, 1214
    s_lshr_b32 s25, s25, 15
    s_mul_i32 s26, s25, 27
    s_sub_u32 s26, s24, s26
    s_and_b32 s27, s23, 1
    s_lshl_b32 s26, s26, 1
    s_add_u32 s26, s26, s27
    s_mul_i32 s26, s26, 40960
    s_mul_i32 s25, s25, 160
    s_add_u32 s43, s26, s25
    s_mul_i32 s27, s23, 5120
    s_add_u32 s54, s27, 8388608
    s_add_u32 s55, s54, 4096
    buffer_load_dwordx4 v[76:79], v2, s[8:11], s43 offen
    buffer_load_dwordx4 v[80:83], v3, s[8:11], s43 offen
    buffer_load_dwordx4 v[84:87], v4, s[8:11], s43 offen
    buffer_load_dwordx4 v[88:91], v5, s[8:11], s43 offen
    buffer_load_dwordx4 v[92:95], v6, s[8:11], s43 offen
    s_waitcnt vmcnt(19)
    buffer_store_dwordx4 v[16:19], v7, s[12:15], s48 offen offset:0
    s_waitcnt vmcnt(19)
    buffer_store_dwordx4 v[20:23], v7, s[12:15], s48 offen offset:1024
    s_waitcnt vmcnt(19)
    buffer_store_dwordx4 v[24:27], v7, s[12:15], s48 offen offset:2048
    s_waitcnt vmcnt(19)
    buffer_store_dwordx4 v[28:31], v7, s[12:15], s48 offen offset:3072
    s_waitcnt vmcnt(19)
    buffer_store_dwordx4 v[32:35], v7, s[12:15], s49 offen
    s_waitcnt vmcnt(19)
    buffer_store_dwordx4 v[36:39], v7, s[12:15], s50 offen offset:0
    s_waitcnt vmcnt(19)
    buffer_store_dwordx4 v[40:43], v7, s[12:15], s50 offen offset:1024
    s_waitcnt vmcnt(19)
    buffer_store_dwordx4 v[44:47], v7, s[12:15], s50 offen offset:2048
    s_waitcnt vmcnt(19)
    buffer_store_dwordx4 v[48:51], v7, s[12:15], s50 offen offset:3072
    s_waitcnt vmcnt(19)
    buffer_store_dwordx4 v[52:55], v7, s[12:15], s51 offen
    s_waitcnt vmcnt(19)
    buffer_store_dwordx4 v[56:59], v7, s[12:15], s52 offen offset:0
    s_waitcnt vmcnt(19)
    buffer_store_dwordx4 v[60:63], v7, s[12:15], s52 offen offset:1024
    s_waitcnt vmcnt(19)
    buffer_store_dwordx4 v[64:67], v7, s[12:15], s52 offen offset:2048
    s_waitcnt vmcnt(19)
    buffer_store_dwordx4 v[68:71], v7, s[12:15], s52 offen offset:3072
    s_waitcnt vmcnt(19)
    buffer_store_dwordx4 v[72:75], v7, s[12:15], s53 offen
    s_waitcnt vmcnt(19)
    buffer_store_dwordx4 v[76:79], v7, s[12:15], s54 offen offset:0
    s_waitcnt vmcnt(19)
    buffer_store_dwordx4 v[80:83], v7, s[12:15], s54 offen offset:1024
    s_waitcnt vmcnt(19)
    buffer_store_dwordx4 v[84:87], v7, s[12:15], s54 offen offset:2048
    s_waitcnt vmcnt(19)
    buffer_store_dwordx4 v[88:91], v7, s[12:15], s54 offen offset:3072
    s_waitcnt vmcnt(19)
    buffer_store_dwordx4 v[92:95], v7, s[12:15], s55 offen
    s_endpgm
G1_RP3:
    s_waitcnt vmcnt(14)
    buffer_store_dwordx4 v[16:19], v7, s[12:15], s48 offen offset:0
    s_waitcnt vmcnt(14)
    buffer_store_dwordx4 v[20:23], v7, s[12:15], s48 offen offset:1024
    s_waitcnt vmcnt(14)
    buffer_store_dwordx4 v[24:27], v7, s[12:15], s48 offen offset:2048
    s_waitcnt vmcnt(14)
    buffer_store_dwordx4 v[28:31], v7, s[12:15], s48 offen offset:3072
    s_waitcnt vmcnt(14)
    buffer_store_dwordx4 v[32:35], v7, s[12:15], s49 offen
    s_waitcnt vmcnt(14)
    buffer_store_dwordx4 v[36:39], v7, s[12:15], s50 offen offset:0
    s_waitcnt vmcnt(14)
    buffer_store_dwordx4 v[40:43], v7, s[12:15], s50 offen offset:1024
    s_waitcnt vmcnt(14)
    buffer_store_dwordx4 v[44:47], v7, s[12:15], s50 offen offset:2048
    s_waitcnt vmcnt(14)
    buffer_store_dwordx4 v[48:51], v7, s[12:15], s50 offen offset:3072
    s_waitcnt vmcnt(14)
    buffer_store_dwordx4 v[52:55], v7, s[12:15], s51 offen
    s_waitcnt vmcnt(14)
    buffer_store_dwordx4 v[56:59], v7, s[12:15], s52 offen offset:0
    s_waitcnt vmcnt(14)
    buffer_store_dwordx4 v[60:63], v7, s[12:15], s52 offen offset:1024
    s_waitcnt vmcnt(14)
    buffer_store_dwordx4 v[64:67], v7, s[12:15], s52 offen offset:2048
    s_waitcnt vmcnt(14)
    buffer_store_dwordx4 v[68:71], v7, s[12:15], s52 offen offset:3072
    s_waitcnt vmcnt(14)
    buffer_store_dwordx4 v[72:75], v7, s[12:15], s53 offen
G1_END:
    s_endpgm
.section .rodata,"a"
.p2align 6
.amdhsa_kernel gemm1_kernel
  .amdhsa_next_free_vgpr 128
  .amdhsa_next_free_sgpr 64
  .amdhsa_accum_offset 128
  .amdhsa_group_segment_fixed_size 0
  .amdhsa_kernarg_size 48
  .amdhsa_user_sgpr_count 2
  .amdhsa_user_sgpr_kernarg_segment_ptr 1
  .amdhsa_system_sgpr_workgroup_id_x 1
.end_amdhsa_kernel

.text
.globl gemm2_kernel
.p2align 8
.type gemm2_kernel,@function
gemm2_kernel:
    s_cmp_ge_u32 s2, 256
    s_cbranch_scc1 G2_END
    s_load_dwordx4 s[28:31], s[0:1], 16
    s_load_dwordx2 s[32:33], s[0:1], 40
    s_and_b32 s24, s2, 7
    s_lshr_b32 s25, s2, 3
    s_and_b32 s26, s24, 3
    s_lshl_b32 s26, s26, 3
    s_and_b32 s27, s25, 7
    s_add_u32 s26, s26, s27
    s_lshr_b32 s24, s24, 2
    s_lshl_b32 s24, s24, 2
    s_lshr_b32 s25, s25, 3
    s_add_u32 s34, s24, s25
    s_lshl_b32 s20, s26, 6
    s_mul_i32 s21, s34, 80
    v_lshrrev_b32 v1, 6, v0
    v_and_b32 v12, 63, v0
    v_readfirstlane_b32 s19, v1
    v_mov_b32 v1, v12
    v_lshlrev_b32 v2, 4, v1
    s_lshr_b32 s24, s20, 4
    s_mul_i32 s24, s24, 55296
    v_add_u32 v7, s24, v2
    v_add_u32 v8, 55296, v7
    v_add_u32 v9, 110592, v7
    v_add_u32 v10, 165888, v7
    v_lshrrev_b32 v12, 5, v1
    v_lshlrev_b32 v12, 4, v12
    v_lshrrev_b32 v13, 4, v1
    v_and_b32 v13, 1, v13
    v_lshlrev_b32 v13, 2, v13
    v_add_u32 v12, v12, v13
    v_and_b32 v13, 15, v1
    v_lshrrev_b32 v13, 2, v13
    v_add_u32 v12, v12, v13
    v_mul_u32_u24 v12, 160, v12
    v_and_b32 v13, 3, v1
    v_lshlrev_b32 v13, 3, v13
    v_add_u32 v12, v12, v13
    s_mul_i32 s18, s19, 30720
    v_add_u32 v11, s18, v12
    s_mul_i32 s17, s34, 27
    s_add_u32 s17, s17, s19
    s_mul_i32 s17, s17, 10240
    s_add_u32 s17, s17, 8388608
    s_lshl_b32 s23, s19, 11
    s_waitcnt lgkmcnt(0)
    s_mov_b32 s4, s32
    s_and_b32 s5, s33, 0xffff
    s_mov_b32 s6, 7077888
    s_mov_b32 s7, 0x00020000
    s_mov_b32 s8, s32
    s_and_b32 s9, s33, 0xffff
    s_mov_b32 s10, 10600448
    s_mov_b32 s11, 0x00020000
    s_mov_b32 s12, s30
    s_and_b32 s13, s31, 0xffff
    s_mov_b32 s14, 2621440
    s_mov_b32 s15, 0x00020000
    s_nop 4
    s_add_u32 m0, s18, 0
    s_add_u32 s16, s17, 0
    buffer_load_dwordx4 v2, s[8:11], s16 offen lds
    s_add_u32 s22, s23, 0
    buffer_load_dwordx4 v[56:59], v7, s[4:7], s22 offen offset:0
    s_add_u32 m0, s18, 1024
    s_add_u32 s16, s17, 1024
    buffer_load_dwordx4 v2, s[8:11], s16 offen lds
    s_add_u32 s22, s23, 0
    buffer_load_dwordx4 v[60:63], v7, s[4:7], s22 offen offset:1024
    s_add_u32 m0, s18, 2048
    s_add_u32 s16, s17, 2048
    buffer_load_dwordx4 v2, s[8:11], s16 offen lds
    s_add_u32 s22, s23, 0
    buffer_load_dwordx4 v[64:67], v8, s[4:7], s22 offen offset:0
    s_add_u32 m0, s18, 3072
    s_add_u32 s16, s17, 3072
    buffer_load_dwordx4 v2, s[8:11], s16 offen lds
    s_add_u32 s22, s23, 0
    buffer_load_dwordx4 v[68:71], v8, s[4:7], s22 offen offset:1024
    s_add_u32 m0, s18, 4096
    s_add_u32 s16, s17, 4096
    buffer_load_dwordx4 v2, s[8:11], s16 offen lds
    s_add_u32 s22, s23, 0
    buffer_load_dwordx4 v[72:75], v9, s[4:7], s22 offen offset:0
    s_add_u32 m0, s18, 5120
    s_add_u32 s16, s17, 5120
    buffer_load_dwordx4 v2, s[8:11], s16 offen lds
    s_add_u32 s22, s23, 0
    buffer_load_dwordx4 v[76:79], v9, s[4:7], s22 offen offset:1024
    s_add_u32 m0, s18, 6144
    s_add_u32 s16, s17, 6144
    buffer_load_dwordx4 v2, s[8:11], s16 offen lds
    s_add_u32 s22, s23, 0
    buffer_load_dwordx4 v[80:83], v10, s[4:7], s22 offen offset:0
    s_add_u32 m0, s18, 7168
    s_add_u32 s16, s17, 7168
    buffer_load_dwordx4 v2, s[8:11], s16 offen lds
    s_add_u32 s22, s23, 0
    buffer_load_dwordx4 v[84:87], v10, s[4:7], s22 offen offset:1024
    s_add_u32 m0, s18, 8192
    s_add_u32 s16, s17, 8192
    buffer_load_dwordx4 v2, s[8:11], s16 offen lds
    s_add_u32 m0, s18, 9216
    s_add_u32 s16, s17, 9216
    buffer_load_dwordx4 v2, s[8:11], s16 offen lds
    s_add_u32 m0, s18, 10240
    s_add_u32 s16, s17, 40960
    buffer_load_dwordx4 v2, s[8:11], s16 offen lds
    s_add_u32 s22, s23, 8192
    buffer_load_dwordx4 v[88:91], v7, s[4:7], s22 offen offset:0
    s_add_u32 m0, s18, 11264
    s_add_u32 s16, s17, 41984
    buffer_load_dwordx4 v2, s[8:11], s16 offen lds
    s_add_u32 s22, s23, 8192
    buffer_load_dwordx4 v[92:95], v7, s[4:7], s22 offen offset:1024
    s_add_u32 m0, s18, 12288
    s_add_u32 s16, s17, 43008
    buffer_load_dwordx4 v2, s[8:11], s16 offen lds
    s_add_u32 s22, s23, 8192
    buffer_load_dwordx4 v[96:99], v8, s[4:7], s22 offen offset:0
    s_add_u32 m0, s18, 13312
    s_add_u32 s16, s17, 44032
    buffer_load_dwordx4 v2, s[8:11], s16 offen lds
    s_add_u32 s22, s23, 8192
    buffer_load_dwordx4 v[100:103], v8, s[4:7], s22 offen offset:1024
    s_add_u32 m0, s18, 14336
    s_add_u32 s16, s17, 45056
    buffer_load_dwordx4 v2, s[8:11], s16 offen lds
    s_add_u32 s22, s23, 8192
    buffer_load_dwordx4 v[104:107], v9, s[4:7], s22 offen offset:0
    s_add_u32 m0, s18, 15360
    s_add_u32 s16, s17, 46080
    buffer_load_dwordx4 v2, s[8:11], s16 offen lds
    s_add_u32 s22, s23, 8192
    buffer_load_dwordx4 v[108:111], v9, s[4:7], s22 offen offset:1024
    s_add_u32 m0, s18, 16384
    s_add_u32 s16, s17, 47104
    buffer_load_dwordx4 v2, s[8:11], s16 offen lds
    s_add_u32 s22, s23, 8192
    buffer_load_dwordx4 v[112:115], v10, s[4:7], s22 offen offset:0
    s_add_u32 m0, s18, 17408
    s_add_u32 s16, s17, 48128
    buffer_load_dwordx4 v2, s[8:11], s16 offen lds
    s_add_u32 s22, s23, 8192
    buffer_load_dwordx4 v[116:119], v10, s[4:7], s22 offen offset:1024
    s_add_u32 m0, s18, 18432
    s_add_u32 s16, s17, 49152
    buffer_load_dwordx4 v2, s[8:11], s16 offen lds
    s_add_u32 m0, s18, 19456
    s_add_u32 s16, s17, 50176
    buffer_load_dwordx4 v2, s[8:11], s16 offen lds
    s_waitcnt vmcnt(18)
    ds_read_b64_tr_b16 v[16:17], v11 offset:0
    ds_read_b64_tr_b16 v[18:19], v11 offset:1280
    ds_read_b64_tr_b16 v[20:21], v11 offset:32
    ds_read_b64_tr_b16 v[22:23], v11 offset:1312
    ds_read_b64_tr_b16 v[24:25], v11 offset:64
    ds_read_b64_tr_b16 v[26:27], v11 offset:1344
    ds_read_b64_tr_b16 v[28:29], v11 offset:96
    ds_read_b64_tr_b16 v[30:31], v11 offset:1376
    ds_read_b64_tr_b16 v[32:33], v11 offset:128
    ds_read_b64_tr_b16 v[34:35], v11 offset:1408
    s_waitcnt lgkmcnt(0)
    v_mfma_f32_16x16x32_bf16 v[152:155], v[16:19], v[56:59], 0
    v_mfma_f32_16x16x32_bf16 v[156:159], v[20:23], v[56:59], 0
    ds_read_b64_tr_b16 v[36:37], v11 offset:5120
    v_mfma_f32_16x16x32_bf16 v[160:163], v[24:27], v[56:59], 0
    s_add_u32 m0, s18, 20480
    s_add_u32 s16, s17, 81920
    buffer_load_dwordx4 v2, s[8:11], s16 offen lds
    v_mfma_f32_16x16x32_bf16 v[164:167], v[28:31], v[56:59], 0
    ds_read_b64_tr_b16 v[38:39], v11 offset:6400
    v_mfma_f32_16x16x32_bf16 v[168:171], v[32:35], v[56:59], 0
    s_add_u32 s22, s23, 16384
    buffer_load_dwordx4 v[120:123], v7, s[4:7], s22 offen offset:0
    v_mfma_f32_16x16x32_bf16 v[172:175], v[16:19], v[64:67], 0
    ds_read_b64_tr_b16 v[40:41], v11 offset:5152
    v_mfma_f32_16x16x32_bf16 v[176:179], v[20:23], v[64:67], 0
    s_add_u32 m0, s18, 21504
    s_add_u32 s16, s17, 82944
    buffer_load_dwordx4 v2, s[8:11], s16 offen lds
    v_mfma_f32_16x16x32_bf16 v[180:183], v[24:27], v[64:67], 0
    ds_read_b64_tr_b16 v[42:43], v11 offset:6432
    v_mfma_f32_16x16x32_bf16 v[184:187], v[28:31], v[64:67], 0
    s_add_u32 s22, s23, 16384
    buffer_load_dwordx4 v[124:127], v7, s[4:7], s22 offen offset:1024
    v_mfma_f32_16x16x32_bf16 v[188:191], v[32:35], v[64:67], 0
    ds_read_b64_tr_b16 v[44:45], v11 offset:5184
    v_mfma_f32_16x16x32_bf16 v[192:195], v[16:19], v[72:75], 0
    s_add_u32 m0, s18, 22528
    s_add_u32 s16, s17, 83968
    buffer_load_dwordx4 v2, s[8:11], s16 offen lds
    v_mfma_f32_16x16x32_bf16 v[196:199], v[20:23], v[72:75], 0
    ds_read_b64_tr_b16 v[46:47], v11 offset:6464
    v_mfma_f32_16x16x32_bf16 v[200:203], v[24:27], v[72:75], 0
    s_add_u32 s22, s23, 16384
    buffer_load_dwordx4 v[128:131], v8, s[4:7], s22 offen offset:0
    v_mfma_f32_16x16x32_bf16 v[204:207], v[28:31], v[72:75], 0
    ds_read_b64_tr_b16 v[48:49], v11 offset:5216
    v_mfma_f32_16x16x32_bf16 v[208:211], v[32:35], v[72:75], 0
    s_add_u32 m0, s18, 23552
    s_add_u32 s16, s17, 84992
    buffer_load_dwordx4 v2, s[8:11], s16 offen lds
    v_mfma_f32_16x16x32_bf16 v[212:215], v[16:19], v[80:83], 0
    ds_read_b64_tr_b16 v[50:51], v11 offset:6496
    v_mfma_f32_16x16x32_bf16 v[216:219], v[20:23], v[80:83], 0
    s_add_u32 s22, s23, 16384
    buffer_load_dwordx4 v[132:135], v8, s[4:7], s22 offen offset:1024
    v_mfma_f32_16x16x32_bf16 v[220:223], v[24:27], v[80:83], 0
    ds_read_b64_tr_b16 v[52:53], v11 offset:5248
    v_mfma_f32_16x16x32_bf16 v[224:227], v[28:31], v[80:83], 0
    s_add_u32 m0, s18, 24576
    s_add_u32 s16, s17, 86016
    buffer_load_dwordx4 v2, s[8:11], s16 offen lds
    v_mfma_f32_16x16x32_bf16 v[228:231], v[32:35], v[80:83], 0
    ds_read_b64_tr_b16 v[54:55], v11 offset:6528
    s_waitcnt lgkmcnt(0)
    s_waitcnt vmcnt(9)
    v_mfma_f32_16x16x32_bf16 v[152:155], v[36:39], v[60:63], v[152:155]
    v_mfma_f32_16x16x32_bf16 v[156:159], v[40:43], v[60:63], v[156:159]
    ds_read_b64_tr_b16 v[16:17], v11 offset:10240
    v_mfma_f32_16x16x32_bf16 v[160:163], v[44:47], v[60:63], v[160:163]
    s_add_u32 s22, s23, 16384
    buffer_load_dwordx4 v[136:139], v9, s[4:7], s22 offen offset:0
    v_mfma_f32_16x16x32_bf16 v[164:167], v[48:51], v[60:63], v[164:167]
    ds_read_b64_tr_b16 v[18:19], v11 offset:11520
    v_mfma_f32_16x16x32_bf16 v[168:171], v[52:55], v[60:63], v[168:171]
    s_add_u32 m0, s18, 25600
    s_add_u32 s16, s17, 87040
    buffer_load_dwordx4 v2, s[8:11], s16 offen lds
    v_mfma_f32_16x16x32_bf16 v[172:175], v[36:39], v[68:71], v[172:175]
    ds_read_b64_tr_b16 v[20:21], v11 offset:10272
    v_mfma_f32_16x16x32_bf16 v[176:179], v[40:43], v[68:71], v[176:179]
    s_add_u32 s22, s23, 16384
    buffer_load_dwordx4 v[140:143], v9, s[4:7], s22 offen offset:1024
    v_mfma_f32_16x16x32_bf16 v[180:183], v[44:47], v[68:71], v[180:183]
    ds_read_b64_tr_b16 v[22:23], v11 offset:11552
    v_mfma_f32_16x16x32_bf16 v[184:187], v[48:51], v[68:71], v[184:187]
    s_add_u32 m0, s18, 26624
    s_add_u32 s16, s17, 88064
    buffer_load_dwordx4 v2, s[8:11], s16 offen lds
    v_mfma_f32_16x16x32_bf16 v[188:191], v[52:55], v[68:71], v[188:191]
    ds_read_b64_tr_b16 v[24:25], v11 offset:10304
    v_mfma_f32_16x16x32_bf16 v[192:195], v[36:39], v[76:79], v[192:195]
    s_add_u32 s22, s23, 16384
    buffer_load_dwordx4 v[144:147], v10, s[4:7], s22 offen offset:0
    v_mfma_f32_16x16x32_bf16 v[196:199], v[40:43], v[76:79], v[196:199]
    ds_read_b64_tr_b16 v[26:27], v11 offset:11584
    v_mfma_f32_16x16x32_bf16 v[200:203], v[44:47], v[76:79], v[200:203]
    s_add_u32 m0, s18, 27648
    s_add_u32 s16, s17, 89088
    buffer_load_dwordx4 v2, s[8:11], s16 offen lds
    v_mfma_f32_16x16x32_bf16 v[204:207], v[48:51], v[76:79], v[204:207]
    ds_read_b64_tr_b16 v[28:29], v11 offset:10336
    v_mfma_f32_16x16x32_bf16 v[208:211], v[52:55], v[76:79], v[208:211]
    s_add_u32 s22, s23, 16384
    buffer_load_dwordx4 v[148:151], v10, s[4:7], s22 offen offset:1024
    v_mfma_f32_16x16x32_bf16 v[212:215], v[36:39], v[84:87], v[212:215]
    ds_read_b64_tr_b16 v[30:31], v11 offset:11616
    v_mfma_f32_16x16x32_bf16 v[216:219], v[40:43], v[84:87], v[216:219]
    s_add_u32 m0, s18, 28672
    s_add_u32 s16, s17, 90112
    buffer_load_dwordx4 v2, s[8:11], s16 offen lds
    v_mfma_f32_16x16x32_bf16 v[220:223], v[44:47], v[84:87], v[220:223]
    ds_read_b64_tr_b16 v[32:33], v11 offset:10368
    v_mfma_f32_16x16x32_bf16 v[224:227], v[48:51], v[84:87], v[224:227]
    s_add_u32 m0, s18, 29696
    s_add_u32 s16, s17, 91136
    buffer_load_dwordx4 v2, s[8:11], s16 offen lds
    v_mfma_f32_16x16x32_bf16 v[228:231], v[52:55], v[84:87], v[228:231]
    ds_read_b64_tr_b16 v[34:35], v11 offset:11648
    s_waitcnt lgkmcnt(0)
    v_mfma_f32_16x16x32_bf16 v[152:155], v[16:19], v[88:91], v[152:155]
    v_mfma_f32_16x16x32_bf16 v[156:159], v[20:23], v[88:91], v[156:159]
    ds_read_b64_tr_b16 v[36:37], v11 offset:15360
    v_mfma_f32_16x16x32_bf16 v[160:163], v[24:27], v[88:91], v[160:163]
    s_add_u32 m0, s18, 0
    s_add_u32 s16, s17, 122880
    buffer_load_dwordx4 v2, s[8:11], s16 offen lds
    v_mfma_f32_16x16x32_bf16 v[164:167], v[28:31], v[88:91], v[164:167]
    ds_read_b64_tr_b16 v[38:39], v11 offset:16640
    v_mfma_f32_16x16x32_bf16 v[168:171], v[32:35], v[88:91], v[168:171]
    s_add_u32 s22, s23, 24576
    buffer_load_dwordx4 v[56:59], v7, s[4:7], s22 offen offset:0
    v_mfma_f32_16x16x32_bf16 v[172:175], v[16:19], v[96:99], v[172:175]
    ds_read_b64_tr_b16 v[40:41], v11 offset:15392
    v_mfma_f32_16x16x32_bf16 v[176:179], v[20:23], v[96:99], v[176:179]
    s_add_u32 m0, s18, 1024
    s_add_u32 s16, s17, 123904
    buffer_load_dwordx4 v2, s[8:11], s16 offen lds
    v_mfma_f32_16x16x32_bf16 v[180:183], v[24:27], v[96:99], v[180:183]
    ds_read_b64_tr_b16 v[42:43], v11 offset:16672
    v_mfma_f32_16x16x32_bf16 v[184:187], v[28:31], v[96:99], v[184:187]
    s_add_u32 s22, s23, 24576
    buffer_load_dwordx4 v[60:63], v7, s[4:7], s22 offen offset:1024
    v_mfma_f32_16x16x32_bf16 v[188:191], v[32:35], v[96:99], v[188:191]
    ds_read_b64_tr_b16 v[44:45], v11 offset:15424
    v_mfma_f32_16x16x32_bf16 v[192:195], v[16:19], v[104:107], v[192:195]
    s_add_u32 m0, s18, 2048
    s_add_u32 s16, s17, 124928
    buffer_load_dwordx4 v2, s[8:11], s16 offen lds
    v_mfma_f32_16x16x32_bf16 v[196:199], v[20:23], v[104:107], v[196:199]
    ds_read_b64_tr_b16 v[46:47], v11 offset:16704
    v_mfma_f32_16x16x32_bf16 v[200:203], v[24:27], v[104:107], v[200:203]
    s_add_u32 s22, s23, 24576
    buffer_load_dwordx4 v[64:67], v8, s[4:7], s22 offen offset:0
    v_mfma_f32_16x16x32_bf16 v[204:207], v[28:31], v[104:107], v[204:207]
    ds_read_b64_tr_b16 v[48:49], v11 offset:15456
    v_mfma_f32_16x16x32_bf16 v[208:211], v[32:35], v[104:107], v[208:211]
    s_add_u32 m0, s18, 3072
    s_add_u32 s16, s17, 125952
    buffer_load_dwordx4 v2, s[8:11], s16 offen lds
    v_mfma_f32_16x16x32_bf16 v[212:215], v[16:19], v[112:115], v[212:215]
    ds_read_b64_tr_b16 v[50:51], v11 offset:16736
    v_mfma_f32_16x16x32_bf16 v[216:219], v[20:23], v[112:115], v[216:219]
    s_add_u32 s22, s23, 24576
    buffer_load_dwordx4 v[68:71], v8, s[4:7], s22 offen offset:1024
    v_mfma_f32_16x16x32_bf16 v[220:223], v[24:27], v[112:115], v[220:223]
    ds_read_b64_tr_b16 v[52:53], v11 offset:15488
    v_mfma_f32_16x16x32_bf16 v[224:227], v[28:31], v[112:115], v[224:227]
    s_add_u32 m0, s18, 4096
    s_add_u32 s16, s17, 126976
    buffer_load_dwordx4 v2, s[8:11], s16 offen lds
    v_mfma_f32_16x16x32_bf16 v[228:231], v[32:35], v[112:115], v[228:231]
    ds_read_b64_tr_b16 v[54:55], v11 offset:16768
    s_waitcnt lgkmcnt(0)
    s_waitcnt vmcnt(9)
    v_mfma_f32_16x16x32_bf16 v[152:155], v[36:39], v[92:95], v[152:155]
    v_mfma_f32_16x16x32_bf16 v[156:159], v[40:43], v[92:95], v[156:159]
    ds_read_b64_tr_b16 v[16:17], v11 offset:20480
    v_mfma_f32_16x16x32_bf16 v[160:163], v[44:47], v[92:95], v[160:163]
    s_add_u32 s22, s23, 24576
    buffer_load_dwordx4 v[72:75], v9, s[4:7], s22 offen offset:0
    v_mfma_f32_16x16x32_bf16 v[164:167], v[48:51], v[92:95], v[164:167]
    ds_read_b64_tr_b16 v[18:19], v11 offset:21760
    v_mfma_f32_16x16x32_bf16 v[168:171], v[52:55], v[92:95], v[168:171]
    s_add_u32 m0, s18, 5120
    s_add_u32 s16, s17, 128000
    buffer_load_dwordx4 v2, s[8:11], s16 offen lds
    v_mfma_f32_16x16x32_bf16 v[172:175], v[36:39], v[100:103], v[172:175]
    ds_read_b64_tr_b16 v[20:21], v11 offset:20512
    v_mfma_f32_16x16x32_bf16 v[176:179], v[40:43], v[100:103], v[176:179]
    s_add_u32 s22, s23, 24576
    buffer_load_dwordx4 v[76:79], v9, s[4:7], s22 offen offset:1024
    v_mfma_f32_16x16x32_bf16 v[180:183], v[44:47], v[100:103], v[180:183]
    ds_read_b64_tr_b16 v[22:23], v11 offset:21792
    v_mfma_f32_16x16x32_bf16 v[184:187], v[48:51], v[100:103], v[184:187]
    s_add_u32 m0, s18, 6144
    s_add_u32 s16, s17, 129024
    buffer_load_dwordx4 v2, s[8:11], s16 offen lds
    v_mfma_f32_16x16x32_bf16 v[188:191], v[52:55], v[100:103], v[188:191]
    ds_read_b64_tr_b16 v[24:25], v11 offset:20544
    v_mfma_f32_16x16x32_bf16 v[192:195], v[36:39], v[108:111], v[192:195]
    s_add_u32 s22, s23, 24576
    buffer_load_dwordx4 v[80:83], v10, s[4:7], s22 offen offset:0
    v_mfma_f32_16x16x32_bf16 v[196:199], v[40:43], v[108:111], v[196:199]
    ds_read_b64_tr_b16 v[26:27], v11 offset:21824
    v_mfma_f32_16x16x32_bf16 v[200:203], v[44:47], v[108:111], v[200:203]
    s_add_u32 m0, s18, 7168
    s_add_u32 s16, s17, 130048
    buffer_load_dwordx4 v2, s[8:11], s16 offen lds
    v_mfma_f32_16x16x32_bf16 v[204:207], v[48:51], v[108:111], v[204:207]
    ds_read_b64_tr_b16 v[28:29], v11 offset:20576
    v_mfma_f32_16x16x32_bf16 v[208:211], v[52:55], v[108:111], v[208:211]
    s_add_u32 s22, s23, 24576
    buffer_load_dwordx4 v[84:87], v10, s[4:7], s22 offen offset:1024
    v_mfma_f32_16x16x32_bf16 v[212:215], v[36:39], v[116:119], v[212:215]
    ds_read_b64_tr_b16 v[30:31], v11 offset:21856
    v_mfma_f32_16x16x32_bf16 v[216:219], v[40:43], v[116:119], v[216:219]
    s_add_u32 m0, s18, 8192
    s_add_u32 s16, s17, 131072
    buffer_load_dwordx4 v2, s[8:11], s16 offen lds
    v_mfma_f32_16x16x32_bf16 v[220:223], v[44:47], v[116:119], v[220:223]
    ds_read_b64_tr_b16 v[32:33], v11 offset:20608
    v_mfma_f32_16x16x32_bf16 v[224:227], v[48:51], v[116:119], v[224:227]
    s_add_u32 m0, s18, 9216
    s_add_u32 s16, s17, 132096
    buffer_load_dwordx4 v2, s[8:11], s16 offen lds
    v_mfma_f32_16x16x32_bf16 v[228:231], v[52:55], v[116:119], v[228:231]
    ds_read_b64_tr_b16 v[34:35], v11 offset:21888
    s_waitcnt lgkmcnt(0)
    v_mfma_f32_16x16x32_bf16 v[152:155], v[16:19], v[120:123], v[152:155]
    v_mfma_f32_16x16x32_bf16 v[156:159], v[20:23], v[120:123], v[156:159]
    ds_read_b64_tr_b16 v[36:37], v11 offset:25600
    v_mfma_f32_16x16x32_bf16 v[160:163], v[24:27], v[120:123], v[160:163]
    s_add_u32 m0, s18, 10240
    s_add_u32 s16, s17, 163840
    buffer_load_dwordx4 v2, s[8:11], s16 offen lds
    v_mfma_f32_16x16x32_bf16 v[164:167], v[28:31], v[120:123], v[164:167]
    ds_read_b64_tr_b16 v[38:39], v11 offset:26880
    v_mfma_f32_16x16x32_bf16 v[168:171], v[32:35], v[120:123], v[168:171]
    s_add_u32 s22, s23, 32768
    buffer_load_dwordx4 v[88:91], v7, s[4:7], s22 offen offset:0
    v_mfma_f32_16x16x32_bf16 v[172:175], v[16:19], v[128:131], v[172:175]
    ds_read_b64_tr_b16 v[40:41], v11 offset:25632
    v_mfma_f32_16x16x32_bf16 v[176:179], v[20:23], v[128:131], v[176:179]
    s_add_u32 m0, s18, 11264
    s_add_u32 s16, s17, 164864
    buffer_load_dwordx4 v2, s[8:11], s16 offen lds
    v_mfma_f32_16x16x32_bf16 v[180:183], v[24:27], v[128:131], v[180:183]
    ds_read_b64_tr_b16 v[42:43], v11 offset:26912
    v_mfma_f32_16x16x32_bf16 v[184:187], v[28:31], v[128:131], v[184:187]
    s_add_u32 s22, s23, 32768
    buffer_load_dwordx4 v[92:95], v7, s[4:7], s22 offen offset:1024
    v_mfma_f32_16x16x32_bf16 v[188:191], v[32:35], v[128:131], v[188:191]
    ds_read_b64_tr_b16 v[44:45], v11 offset:25664
    v_mfma_f32_16x16x32_bf16 v[192:195], v[16:19], v[136:139], v[192:195]
    s_add_u32 m0, s18, 12288
    s_add_u32 s16, s17, 165888
    buffer_load_dwordx4 v2, s[8:11], s16 offen lds
    v_mfma_f32_16x16x32_bf16 v[196:199], v[20:23], v[136:139], v[196:199]
    ds_read_b64_tr_b16 v[46:47], v11 offset:26944
    v_mfma_f32_16x16x32_bf16 v[200:203], v[24:27], v[136:139], v[200:203]
    s_add_u32 s22, s23, 32768
    buffer_load_dwordx4 v[96:99], v8, s[4:7], s22 offen offset:0
    v_mfma_f32_16x16x32_bf16 v[204:207], v[28:31], v[136:139], v[204:207]
    ds_read_b64_tr_b16 v[48:49], v11 offset:25696
    v_mfma_f32_16x16x32_bf16 v[208:211], v[32:35], v[136:139], v[208:211]
    s_add_u32 m0, s18, 13312
    s_add_u32 s16, s17, 166912
    buffer_load_dwordx4 v2, s[8:11], s16 offen lds
    v_mfma_f32_16x16x32_bf16 v[212:215], v[16:19], v[144:147], v[212:215]
    ds_read_b64_tr_b16 v[50:51], v11 offset:26976
    v_mfma_f32_16x16x32_bf16 v[216:219], v[20:23], v[144:147], v[216:219]
    s_add_u32 s22, s23, 32768
    buffer_load_dwordx4 v[100:103], v8, s[4:7], s22 offen offset:1024
    v_mfma_f32_16x16x32_bf16 v[220:223], v[24:27], v[144:147], v[220:223]
    ds_read_b64_tr_b16 v[52:53], v11 offset:25728
    v_mfma_f32_16x16x32_bf16 v[224:227], v[28:31], v[144:147], v[224:227]
    s_add_u32 m0, s18, 14336
    s_add_u32 s16, s17, 167936
    buffer_load_dwordx4 v2, s[8:11], s16 offen lds
    v_mfma_f32_16x16x32_bf16 v[228:231], v[32:35], v[144:147], v[228:231]
    ds_read_b64_tr_b16 v[54:55], v11 offset:27008
    s_waitcnt lgkmcnt(0)
    s_waitcnt vmcnt(9)
    v_mfma_f32_16x16x32_bf16 v[152:155], v[36:39], v[124:127], v[152:155]
    v_mfma_f32_16x16x32_bf16 v[156:159], v[40:43], v[124:127], v[156:159]
    ds_read_b64_tr_b16 v[16:17], v11 offset:0
    v_mfma_f32_16x16x32_bf16 v[160:163], v[44:47], v[124:127], v[160:163]
    s_add_u32 s22, s23, 32768
    buffer_load_dwordx4 v[104:107], v9, s[4:7], s22 offen offset:0
    v_mfma_f32_16x16x32_bf16 v[164:167], v[48:51], v[124:127], v[164:167]
    ds_read_b64_tr_b16 v[18:19], v11 offset:1280
    v_mfma_f32_16x16x32_bf16 v[168:171], v[52:55], v[124:127], v[168:171]
    s_add_u32 m0, s18, 15360
    s_add_u32 s16, s17, 168960
    buffer_load_dwordx4 v2, s[8:11], s16 offen lds
    v_mfma_f32_16x16x32_bf16 v[172:175], v[36:39], v[132:135], v[172:175]
    ds_read_b64_tr_b16 v[20:21], v11 offset:32
    v_mfma_f32_16x16x32_bf16 v[176:179], v[40:43], v[132:135], v[176:179]
    s_add_u32 s22, s23, 32768
    buffer_load_dwordx4 v[108:111], v9, s[4:7], s22 offen offset:1024
    v_mfma_f32_16x16x32_bf16 v[180:183], v[44:47], v[132:135], v[180:183]
    ds_read_b64_tr_b16 v[22:23], v11 offset:1312
    v_mfma_f32_16x16x32_bf16 v[184:187], v[48:51], v[132:135], v[184:187]
    s_add_u32 m0, s18, 16384
    s_add_u32 s16, s17, 169984
    buffer_load_dwordx4 v2, s[8:11], s16 offen lds
    v_mfma_f32_16x16x32_bf16 v[188:191], v[52:55], v[132:135], v[188:191]
    ds_read_b64_tr_b16 v[24:25], v11 offset:64
    v_mfma_f32_16x16x32_bf16 v[192:195], v[36:39], v[140:143], v[192:195]
    s_add_u32 s22, s23, 32768
    buffer_load_dwordx4 v[112:115], v10, s[4:7], s22 offen offset:0
    v_mfma_f32_16x16x32_bf16 v[196:199], v[40:43], v[140:143], v[196:199]
    ds_read_b64_tr_b16 v[26:27], v11 offset:1344
    v_mfma_f32_16x16x32_bf16 v[200:203], v[44:47], v[140:143], v[200:203]
    s_add_u32 m0, s18, 17408
    s_add_u32 s16, s17, 171008
    buffer_load_dwordx4 v2, s[8:11], s16 offen lds
    v_mfma_f32_16x16x32_bf16 v[204:207], v[48:51], v[140:143], v[204:207]
    ds_read_b64_tr_b16 v[28:29], v11 offset:96
    v_mfma_f32_16x16x32_bf16 v[208:211], v[52:55], v[140:143], v[208:211]
    s_add_u32 s22, s23, 32768
    buffer_load_dwordx4 v[116:119], v10, s[4:7], s22 offen offset:1024
    v_mfma_f32_16x16x32_bf16 v[212:215], v[36:39], v[148:151], v[212:215]
    ds_read_b64_tr_b16 v[30:31], v11 offset:1376
    v_mfma_f32_16x16x32_bf16 v[216:219], v[40:43], v[148:151], v[216:219]
    s_add_u32 m0, s18, 18432
    s_add_u32 s16, s17, 172032
    buffer_load_dwordx4 v2, s[8:11], s16 offen lds
    v_mfma_f32_16x16x32_bf16 v[220:223], v[44:47], v[148:151], v[220:223]
    ds_read_b64_tr_b16 v[32:33], v11 offset:128
    v_mfma_f32_16x16x32_bf16 v[224:227], v[48:51], v[148:151], v[224:227]
    s_add_u32 m0, s18, 19456
    s_add_u32 s16, s17, 173056
    buffer_load_dwordx4 v2, s[8:11], s16 offen lds
    v_mfma_f32_16x16x32_bf16 v[228:231], v[52:55], v[148:151], v[228:231]
    ds_read_b64_tr_b16 v[34:35], v11 offset:1408
    s_waitcnt lgkmcnt(0)
    v_mfma_f32_16x16x32_bf16 v[152:155], v[16:19], v[56:59], v[152:155]
    v_mfma_f32_16x16x32_bf16 v[156:159], v[20:23], v[56:59], v[156:159]
    ds_read_b64_tr_b16 v[36:37], v11 offset:5120
    v_mfma_f32_16x16x32_bf16 v[160:163], v[24:27], v[56:59], v[160:163]
    s_add_u32 m0, s18, 20480
    s_add_u32 s16, s17, 204800
    buffer_load_dwordx4 v2, s[8:11], s16 offen lds
    v_mfma_f32_16x16x32_bf16 v[164:167], v[28:31], v[56:59], v[164:167]
    ds_read_b64_tr_b16 v[38:39], v11 offset:6400
    v_mfma_f32_16x16x32_bf16 v[168:171], v[32:35], v[56:59], v[168:171]
    s_add_u32 s22, s23, 40960
    buffer_load_dwordx4 v[120:123], v7, s[4:7], s22 offen offset:0
    v_mfma_f32_16x16x32_bf16 v[172:175], v[16:19], v[64:67], v[172:175]
    ds_read_b64_tr_b16 v[40:41], v11 offset:5152
    v_mfma_f32_16x16x32_bf16 v[176:179], v[20:23], v[64:67], v[176:179]
    s_add_u32 m0, s18, 21504
    s_add_u32 s16, s17, 205824
    buffer_load_dwordx4 v2, s[8:11], s16 offen lds
    v_mfma_f32_16x16x32_bf16 v[180:183], v[24:27], v[64:67], v[180:183]
    ds_read_b64_tr_b16 v[42:43], v11 offset:6432
    v_mfma_f32_16x16x32_bf16 v[184:187], v[28:31], v[64:67], v[184:187]
    s_add_u32 s22, s23, 40960
    buffer_load_dwordx4 v[124:127], v7, s[4:7], s22 offen offset:1024
    v_mfma_f32_16x16x32_bf16 v[188:191], v[32:35], v[64:67], v[188:191]
    ds_read_b64_tr_b16 v[44:45], v11 offset:5184
    v_mfma_f32_16x16x32_bf16 v[192:195], v[16:19], v[72:75], v[192:195]
    s_add_u32 m0, s18, 22528
    s_add_u32 s16, s17, 206848
    buffer_load_dwordx4 v2, s[8:11], s16 offen lds
    v_mfma_f32_16x16x32_bf16 v[196:199], v[20:23], v[72:75], v[196:199]
    ds_read_b64_tr_b16 v[46:47], v11 offset:6464
    v_mfma_f32_16x16x32_bf16 v[200:203], v[24:27], v[72:75], v[200:203]
    s_add_u32 s22, s23, 40960
    buffer_load_dwordx4 v[128:131], v8, s[4:7], s22 offen offset:0
    v_mfma_f32_16x16x32_bf16 v[204:207], v[28:31], v[72:75], v[204:207]
    ds_read_b64_tr_b16 v[48:49], v11 offset:5216
    v_mfma_f32_16x16x32_bf16 v[208:211], v[32:35], v[72:75], v[208:211]
    s_add_u32 m0, s18, 23552
    s_add_u32 s16, s17, 207872
    buffer_load_dwordx4 v2, s[8:11], s16 offen lds
    v_mfma_f32_16x16x32_bf16 v[212:215], v[16:19], v[80:83], v[212:215]
    ds_read_b64_tr_b16 v[50:51], v11 offset:6496
    v_mfma_f32_16x16x32_bf16 v[216:219], v[20:23], v[80:83], v[216:219]
    s_add_u32 s22, s23, 40960
    buffer_load_dwordx4 v[132:135], v8, s[4:7], s22 offen offset:1024
    v_mfma_f32_16x16x32_bf16 v[220:223], v[24:27], v[80:83], v[220:223]
    ds_read_b64_tr_b16 v[52:53], v11 offset:5248
    v_mfma_f32_16x16x32_bf16 v[224:227], v[28:31], v[80:83], v[224:227]
    s_add_u32 m0, s18, 24576
    s_add_u32 s16, s17, 208896
    buffer_load_dwordx4 v2, s[8:11], s16 offen lds
    v_mfma_f32_16x16x32_bf16 v[228:231], v[32:35], v[80:83], v[228:231]
    ds_read_b64_tr_b16 v[54:55], v11 offset:6528
    s_waitcnt lgkmcnt(0)
    s_waitcnt vmcnt(9)
    v_mfma_f32_16x16x32_bf16 v[152:155], v[36:39], v[60:63], v[152:155]
    v_mfma_f32_16x16x32_bf16 v[156:159], v[40:43], v[60:63], v[156:159]
    ds_read_b64_tr_b16 v[16:17], v11 offset:10240
    v_mfma_f32_16x16x32_bf16 v[160:163], v[44:47], v[60:63], v[160:163]
    s_add_u32 s22, s23, 40960
    buffer_load_dwordx4 v[136:139], v9, s[4:7], s22 offen offset:0
    v_mfma_f32_16x16x32_bf16 v[164:167], v[48:51], v[60:63], v[164:167]
    ds_read_b64_tr_b16 v[18:19], v11 offset:11520
    v_mfma_f32_16x16x32_bf16 v[168:171], v[52:55], v[60:63], v[168:171]
    s_add_u32 m0, s18, 25600
    s_add_u32 s16, s17, 209920
    buffer_load_dwordx4 v2, s[8:11], s16 offen lds
    v_mfma_f32_16x16x32_bf16 v[172:175], v[36:39], v[68:71], v[172:175]
    ds_read_b64_tr_b16 v[20:21], v11 offset:10272
    v_mfma_f32_16x16x32_bf16 v[176:179], v[40:43], v[68:71], v[176:179]
    s_add_u32 s22, s23, 40960
    buffer_load_dwordx4 v[140:143], v9, s[4:7], s22 offen offset:1024
    v_mfma_f32_16x16x32_bf16 v[180:183], v[44:47], v[68:71], v[180:183]
    ds_read_b64_tr_b16 v[22:23], v11 offset:11552
    v_mfma_f32_16x16x32_bf16 v[184:187], v[48:51], v[68:71], v[184:187]
    s_add_u32 m0, s18, 26624
    s_add_u32 s16, s17, 210944
    buffer_load_dwordx4 v2, s[8:11], s16 offen lds
    v_mfma_f32_16x16x32_bf16 v[188:191], v[52:55], v[68:71], v[188:191]
    ds_read_b64_tr_b16 v[24:25], v11 offset:10304
    v_mfma_f32_16x16x32_bf16 v[192:195], v[36:39], v[76:79], v[192:195]
    s_add_u32 s22, s23, 40960
    buffer_load_dwordx4 v[144:147], v10, s[4:7], s22 offen offset:0
    v_mfma_f32_16x16x32_bf16 v[196:199], v[40:43], v[76:79], v[196:199]
    ds_read_b64_tr_b16 v[26:27], v11 offset:11584
    v_mfma_f32_16x16x32_bf16 v[200:203], v[44:47], v[76:79], v[200:203]
    s_add_u32 m0, s18, 27648
    s_add_u32 s16, s17, 211968
    buffer_load_dwordx4 v2, s[8:11], s16 offen lds
    v_mfma_f32_16x16x32_bf16 v[204:207], v[48:51], v[76:79], v[204:207]
    ds_read_b64_tr_b16 v[28:29], v11 offset:10336
    v_mfma_f32_16x16x32_bf16 v[208:211], v[52:55], v[76:79], v[208:211]
    s_add_u32 s22, s23, 40960
    buffer_load_dwordx4 v[148:151], v10, s[4:7], s22 offen offset:1024
    v_mfma_f32_16x16x32_bf16 v[212:215], v[36:39], v[84:87], v[212:215]
    ds_read_b64_tr_b16 v[30:31], v11 offset:11616
    v_mfma_f32_16x16x32_bf16 v[216:219], v[40:43], v[84:87], v[216:219]
    s_add_u32 m0, s18, 28672
    s_add_u32 s16, s17, 212992
    buffer_load_dwordx4 v2, s[8:11], s16 offen lds
    v_mfma_f32_16x16x32_bf16 v[220:223], v[44:47], v[84:87], v[220:223]
    ds_read_b64_tr_b16 v[32:33], v11 offset:10368
    v_mfma_f32_16x16x32_bf16 v[224:227], v[48:51], v[84:87], v[224:227]
    s_add_u32 m0, s18, 29696
    s_add_u32 s16, s17, 214016
    buffer_load_dwordx4 v2, s[8:11], s16 offen lds
    v_mfma_f32_16x16x32_bf16 v[228:231], v[52:55], v[84:87], v[228:231]
    ds_read_b64_tr_b16 v[34:35], v11 offset:11648
    s_cmp_eq_u32 s19, 3
    s_cbranch_scc1 G2_SHORT
    s_waitcnt lgkmcnt(0)
    v_mfma_f32_16x16x32_bf16 v[152:155], v[16:19], v[88:91], v[152:155]
    v_mfma_f32_16x16x32_bf16 v[156:159], v[20:23], v[88:91], v[156:159]
    ds_read_b64_tr_b16 v[36:37], v11 offset:15360
    v_mfma_f32_16x16x32_bf16 v[160:163], v[24:27], v[88:91], v[160:163]
    s_add_u32 m0, s18, 0
    s_add_u32 s16, s17, 245760
    buffer_load_dwordx4 v2, s[8:11], s16 offen lds
    v_mfma_f32_16x16x32_bf16 v[164:167], v[28:31], v[88:91], v[164:167]
    ds_read_b64_tr_b16 v[38:39], v11 offset:16640
    v_mfma_f32_16x16x32_bf16 v[168:171], v[32:35], v[88:91], v[168:171]
    s_add_u32 s22, s23, 49152
    buffer_load_dwordx4 v[56:59], v7, s[4:7], s22 offen offset:0
    v_mfma_f32_16x16x32_bf16 v[172:175], v[16:19], v[96:99], v[172:175]
    ds_read_b64_tr_b16 v[40:41], v11 offset:15392
    v_mfma_f32_16x16x32_bf16 v[176:179], v[20:23], v[96:99], v[176:179]
    s_add_u32 m0, s18, 1024
    s_add_u32 s16, s17, 246784
    buffer_load_dwordx4 v2, s[8:11], s16 offen lds
    v_mfma_f32_16x16x32_bf16 v[180:183], v[24:27], v[96:99], v[180:183]
    ds_read_b64_tr_b16 v[42:43], v11 offset:16672
    v_mfma_f32_16x16x32_bf16 v[184:187], v[28:31], v[96:99], v[184:187]
    s_add_u32 s22, s23, 49152
    buffer_load_dwordx4 v[60:63], v7, s[4:7], s22 offen offset:1024
    v_mfma_f32_16x16x32_bf16 v[188:191], v[32:35], v[96:99], v[188:191]
    ds_read_b64_tr_b16 v[44:45], v11 offset:15424
    v_mfma_f32_16x16x32_bf16 v[192:195], v[16:19], v[104:107], v[192:195]
    s_add_u32 m0, s18, 2048
    s_add_u32 s16, s17, 247808
    buffer_load_dwordx4 v2, s[8:11], s16 offen lds
    v_mfma_f32_16x16x32_bf16 v[196:199], v[20:23], v[104:107], v[196:199]
    ds_read_b64_tr_b16 v[46:47], v11 offset:16704
    v_mfma_f32_16x16x32_bf16 v[200:203], v[24:27], v[104:107], v[200:203]
    s_add_u32 s22, s23, 49152
    buffer_load_dwordx4 v[64:67], v8, s[4:7], s22 offen offset:0
    v_mfma_f32_16x16x32_bf16 v[204:207], v[28:31], v[104:107], v[204:207]
    ds_read_b64_tr_b16 v[48:49], v11 offset:15456
    v_mfma_f32_16x16x32_bf16 v[208:211], v[32:35], v[104:107], v[208:211]
    s_add_u32 m0, s18, 3072
    s_add_u32 s16, s17, 248832
    buffer_load_dwordx4 v2, s[8:11], s16 offen lds
    v_mfma_f32_16x16x32_bf16 v[212:215], v[16:19], v[112:115], v[212:215]
    ds_read_b64_tr_b16 v[50:51], v11 offset:16736
    v_mfma_f32_16x16x32_bf16 v[216:219], v[20:23], v[112:115], v[216:219]
    s_add_u32 s22, s23, 49152
    buffer_load_dwordx4 v[68:71], v8, s[4:7], s22 offen offset:1024
    v_mfma_f32_16x16x32_bf16 v[220:223], v[24:27], v[112:115], v[220:223]
    ds_read_b64_tr_b16 v[52:53], v11 offset:15488
    v_mfma_f32_16x16x32_bf16 v[224:227], v[28:31], v[112:115], v[224:227]
    s_add_u32 m0, s18, 4096
    s_add_u32 s16, s17, 249856
    buffer_load_dwordx4 v2, s[8:11], s16 offen lds
    v_mfma_f32_16x16x32_bf16 v[228:231], v[32:35], v[112:115], v[228:231]
    ds_read_b64_tr_b16 v[54:55], v11 offset:16768
    s_waitcnt lgkmcnt(0)
    s_waitcnt vmcnt(9)
    v_mfma_f32_16x16x32_bf16 v[152:155], v[36:39], v[92:95], v[152:155]
    v_mfma_f32_16x16x32_bf16 v[156:159], v[40:43], v[92:95], v[156:159]
    ds_read_b64_tr_b16 v[16:17], v11 offset:20480
    v_mfma_f32_16x16x32_bf16 v[160:163], v[44:47], v[92:95], v[160:163]
    s_add_u32 s22, s23, 49152
    buffer_load_dwordx4 v[72:75], v9, s[4:7], s22 offen offset:0
    v_mfma_f32_16x16x32_bf16 v[164:167], v[48:51], v[92:95], v[164:167]
    ds_read_b64_tr_b16 v[18:19], v11 offset:21760
    v_mfma_f32_16x16x32_bf16 v[168:171], v[52:55], v[92:95], v[168:171]
    s_add_u32 m0, s18, 5120
    s_add_u32 s16, s17, 250880
    buffer_load_dwordx4 v2, s[8:11], s16 offen lds
    v_mfma_f32_16x16x32_bf16 v[172:175], v[36:39], v[100:103], v[172:175]
    ds_read_b64_tr_b16 v[20:21], v11 offset:20512
    v_mfma_f32_16x16x32_bf16 v[176:179], v[40:43], v[100:103], v[176:179]
    s_add_u32 s22, s23, 49152
    buffer_load_dwordx4 v[76:79], v9, s[4:7], s22 offen offset:1024
    v_mfma_f32_16x16x32_bf16 v[180:183], v[44:47], v[100:103], v[180:183]
    ds_read_b64_tr_b16 v[22:23], v11 offset:21792
    v_mfma_f32_16x16x32_bf16 v[184:187], v[48:51], v[100:103], v[184:187]
    s_add_u32 m0, s18, 6144
    s_add_u32 s16, s17, 251904
    buffer_load_dwordx4 v2, s[8:11], s16 offen lds
    v_mfma_f32_16x16x32_bf16 v[188:191], v[52:55], v[100:103], v[188:191]
    ds_read_b64_tr_b16 v[24:25], v11 offset:20544
    v_mfma_f32_16x16x32_bf16 v[192:195], v[36:39], v[108:111], v[192:195]
    s_add_u32 s22, s23, 49152
    buffer_load_dwordx4 v[80:83], v10, s[4:7], s22 offen offset:0
    v_mfma_f32_16x16x32_bf16 v[196:199], v[40:43], v[108:111], v[196:199]
    ds_read_b64_tr_b16 v[26:27], v11 offset:21824
    v_mfma_f32_16x16x32_bf16 v[200:203], v[44:47], v[108:111], v[200:203]
    s_add_u32 m0, s18, 7168
    s_add_u32 s16, s17, 252928
    buffer_load_dwordx4 v2, s[8:11], s16 offen lds
    v_mfma_f32_16x16x32_bf16 v[204:207], v[48:51], v[108:111], v[204:207]
    ds_read_b64_tr_b16 v[28:29], v11 offset:20576
    v_mfma_f32_16x16x32_bf16 v[208:211], v[52:55], v[108:111], v[208:211]
    s_add_u32 s22, s23, 49152
    buffer_load_dwordx4 v[84:87], v10, s[4:7], s22 offen offset:1024
    v_mfma_f32_16x16x32_bf16 v[212:215], v[36:39], v[116:119], v[212:215]
    ds_read_b64_tr_b16 v[30:31], v11 offset:21856
    v_mfma_f32_16x16x32_bf16 v[216:219], v[40:43], v[116:119], v[216:219]
    s_add_u32 m0, s18, 8192
    s_add_u32 s16, s17, 253952
    buffer_load_dwordx4 v2, s[8:11], s16 offen lds
    v_mfma_f32_16x16x32_bf16 v[220:223], v[44:47], v[116:119], v[220:223]
    ds_read_b64_tr_b16 v[32:33], v11 offset:20608
    v_mfma_f32_16x16x32_bf16 v[224:227], v[48:51], v[116:119], v[224:227]
    s_add_u32 m0, s18, 9216
    s_add_u32 s16, s17, 254976
    buffer_load_dwordx4 v2, s[8:11], s16 offen lds
    v_mfma_f32_16x16x32_bf16 v[228:231], v[52:55], v[116:119], v[228:231]
    ds_read_b64_tr_b16 v[34:35], v11 offset:21888
    s_waitcnt lgkmcnt(0)
    v_mfma_f32_16x16x32_bf16 v[152:155], v[16:19], v[120:123], v[152:155]
    v_mfma_f32_16x16x32_bf16 v[156:159], v[20:23], v[120:123], v[156:159]
    ds_read_b64_tr_b16 v[36:37], v11 offset:25600
    v_mfma_f32_16x16x32_bf16 v[160:163], v[24:27], v[120:123], v[160:163]
    v_mfma_f32_16x16x32_bf16 v[164:167], v[28:31], v[120:123], v[164:167]
    ds_read_b64_tr_b16 v[38:39], v11 offset:26880
    v_mfma_f32_16x16x32_bf16 v[168:171], v[32:35], v[120:123], v[168:171]
    v_mfma_f32_16x16x32_bf16 v[172:175], v[16:19], v[128:131], v[172:175]
    ds_read_b64_tr_b16 v[40:41], v11 offset:25632
    v_mfma_f32_16x16x32_bf16 v[176:179], v[20:23], v[128:131], v[176:179]
    v_mfma_f32_16x16x32_bf16 v[180:183], v[24:27], v[128:131], v[180:183]
    ds_read_b64_tr_b16 v[42:43], v11 offset:26912
    v_mfma_f32_16x16x32_bf16 v[184:187], v[28:31], v[128:131], v[184:187]
    v_mfma_f32_16x16x32_bf16 v[188:191], v[32:35], v[128:131], v[188:191]
    ds_read_b64_tr_b16 v[44:45], v11 offset:25664
    v_mfma_f32_16x16x32_bf16 v[192:195], v[16:19], v[136:139], v[192:195]
    v_mfma_f32_16x16x32_bf16 v[196:199], v[20:23], v[136:139], v[196:199]
    ds_read_b64_tr_b16 v[46:47], v11 offset:26944
    v_mfma_f32_16x16x32_bf16 v[200:203], v[24:27], v[136:139], v[200:203]
    v_mfma_f32_16x16x32_bf16 v[204:207], v[28:31], v[136:139], v[204:207]
    ds_read_b64_tr_b16 v[48:49], v11 offset:25696
    v_mfma_f32_16x16x32_bf16 v[208:211], v[32:35], v[136:139], v[208:211]
    v_mfma_f32_16x16x32_bf16 v[212:215], v[16:19], v[144:147], v[212:215]
    ds_read_b64_tr_b16 v[50:51], v11 offset:26976
    v_mfma_f32_16x16x32_bf16 v[216:219], v[20:23], v[144:147], v[216:219]
    v_mfma_f32_16x16x32_bf16 v[220:223], v[24:27], v[144:147], v[220:223]
    ds_read_b64_tr_b16 v[52:53], v11 offset:25728
    v_mfma_f32_16x16x32_bf16 v[224:227], v[28:31], v[144:147], v[224:227]
    v_mfma_f32_16x16x32_bf16 v[228:231], v[32:35], v[144:147], v[228:231]
    ds_read_b64_tr_b16 v[54:55], v11 offset:27008
    s_waitcnt lgkmcnt(0)
    s_waitcnt vmcnt(0)
    v_mfma_f32_16x16x32_bf16 v[152:155], v[36:39], v[124:127], v[152:155]
    v_mfma_f32_16x16x32_bf16 v[156:159], v[40:43], v[124:127], v[156:159]
    ds_read_b64_tr_b16 v[16:17], v11 offset:0
    v_mfma_f32_16x16x32_bf16 v[160:163], v[44:47], v[124:127], v[160:163]
    v_mfma_f32_16x16x32_bf16 v[164:167], v[48:51], v[124:127], v[164:167]
    ds_read_b64_tr_b16 v[18:19], v11 offset:1280
    v_mfma_f32_16x16x32_bf16 v[168:171], v[52:55], v[124:127], v[168:171]
    v_mfma_f32_16x16x32_bf16 v[172:175], v[36:39], v[132:135], v[172:175]
    ds_read_b64_tr_b16 v[20:21], v11 offset:32
    v_mfma_f32_16x16x32_bf16 v[176:179], v[40:43], v[132:135], v[176:179]
    v_mfma_f32_16x16x32_bf16 v[180:183], v[44:47], v[132:135], v[180:183]
    ds_read_b64_tr_b16 v[22:23], v11 offset:1312
    v_mfma_f32_16x16x32_bf16 v[184:187], v[48:51], v[132:135], v[184:187]
    v_mfma_f32_16x16x32_bf16 v[188:191], v[52:55], v[132:135], v[188:191]
    ds_read_b64_tr_b16 v[24:25], v11 offset:64
    v_mfma_f32_16x16x32_bf16 v[192:195], v[36:39], v[140:143], v[192:195]
    v_mfma_f32_16x16x32_bf16 v[196:199], v[40:43], v[140:143], v[196:199]
    ds_read_b64_tr_b16 v[26:27], v11 offset:1344
    v_mfma_f32_16x16x32_bf16 v[200:203], v[44:47], v[140:143], v[200:203]
    v_mfma_f32_16x16x32_bf16 v[204:207], v[48:51], v[140:143], v[204:207]
    ds_read_b64_tr_b16 v[28:29], v11 offset:96
    v_mfma_f32_16x16x32_bf16 v[208:211], v[52:55], v[140:143], v[208:211]
    v_mfma_f32_16x16x32_bf16 v[212:215], v[36:39], v[148:151], v[212:215]
    ds_read_b64_tr_b16 v[30:31], v11 offset:1376
    v_mfma_f32_16x16x32_bf16 v[216:219], v[40:43], v[148:151], v[216:219]
    v_mfma_f32_16x16x32_bf16 v[220:223], v[44:47], v[148:151], v[220:223]
    ds_read_b64_tr_b16 v[32:33], v11 offset:128
    v_mfma_f32_16x16x32_bf16 v[224:227], v[48:51], v[148:151], v[224:227]
    v_mfma_f32_16x16x32_bf16 v[228:231], v[52:55], v[148:151], v[228:231]
    ds_read_b64_tr_b16 v[34:35], v11 offset:1408
    s_waitcnt lgkmcnt(0)
    v_mfma_f32_16x16x32_bf16 v[152:155], v[16:19], v[56:59], v[152:155]
    v_mfma_f32_16x16x32_bf16 v[156:159], v[20:23], v[56:59], v[156:159]
    ds_read_b64_tr_b16 v[36:37], v11 offset:5120
    v_mfma_f32_16x16x32_bf16 v[160:163], v[24:27], v[56:59], v[160:163]
    v_mfma_f32_16x16x32_bf16 v[164:167], v[28:31], v[56:59], v[164:167]
    ds_read_b64_tr_b16 v[38:39], v11 offset:6400
    v_mfma_f32_16x16x32_bf16 v[168:171], v[32:35], v[56:59], v[168:171]
    v_mfma_f32_16x16x32_bf16 v[172:175], v[16:19], v[64:67], v[172:175]
    ds_read_b64_tr_b16 v[40:41], v11 offset:5152
    v_mfma_f32_16x16x32_bf16 v[176:179], v[20:23], v[64:67], v[176:179]
    v_mfma_f32_16x16x32_bf16 v[180:183], v[24:27], v[64:67], v[180:183]
    ds_read_b64_tr_b16 v[42:43], v11 offset:6432
    v_mfma_f32_16x16x32_bf16 v[184:187], v[28:31], v[64:67], v[184:187]
    v_mfma_f32_16x16x32_bf16 v[188:191], v[32:35], v[64:67], v[188:191]
    ds_read_b64_tr_b16 v[44:45], v11 offset:5184
    v_mfma_f32_16x16x32_bf16 v[192:195], v[16:19], v[72:75], v[192:195]
    v_mfma_f32_16x16x32_bf16 v[196:199], v[20:23], v[72:75], v[196:199]
    ds_read_b64_tr_b16 v[46:47], v11 offset:6464
    v_mfma_f32_16x16x32_bf16 v[200:203], v[24:27], v[72:75], v[200:203]
    v_mfma_f32_16x16x32_bf16 v[204:207], v[28:31], v[72:75], v[204:207]
    ds_read_b64_tr_b16 v[48:49], v11 offset:5216
    v_mfma_f32_16x16x32_bf16 v[208:211], v[32:35], v[72:75], v[208:211]
    v_mfma_f32_16x16x32_bf16 v[212:215], v[16:19], v[80:83], v[212:215]
    ds_read_b64_tr_b16 v[50:51], v11 offset:6496
    v_mfma_f32_16x16x32_bf16 v[216:219], v[20:23], v[80:83], v[216:219]
    v_mfma_f32_16x16x32_bf16 v[220:223], v[24:27], v[80:83], v[220:223]
    ds_read_b64_tr_b16 v[52:53], v11 offset:5248
    v_mfma_f32_16x16x32_bf16 v[224:227], v[28:31], v[80:83], v[224:227]
    v_mfma_f32_16x16x32_bf16 v[228:231], v[32:35], v[80:83], v[228:231]
    ds_read_b64_tr_b16 v[54:55], v11 offset:6528
    s_waitcnt lgkmcnt(0)
    v_mfma_f32_16x16x32_bf16 v[152:155], v[36:39], v[60:63], v[152:155]
    v_mfma_f32_16x16x32_bf16 v[156:159], v[40:43], v[60:63], v[156:159]
    v_mfma_f32_16x16x32_bf16 v[160:163], v[44:47], v[60:63], v[160:163]
    v_mfma_f32_16x16x32_bf16 v[164:167], v[48:51], v[60:63], v[164:167]
    v_mfma_f32_16x16x32_bf16 v[168:171], v[52:55], v[60:63], v[168:171]
    v_mfma_f32_16x16x32_bf16 v[172:175], v[36:39], v[68:71], v[172:175]
    v_mfma_f32_16x16x32_bf16 v[176:179], v[40:43], v[68:71], v[176:179]
    v_mfma_f32_16x16x32_bf16 v[180:183], v[44:47], v[68:71], v[180:183]
    v_mfma_f32_16x16x32_bf16 v[184:187], v[48:51], v[68:71], v[184:187]
    v_mfma_f32_16x16x32_bf16 v[188:191], v[52:55], v[68:71], v[188:191]
    v_mfma_f32_16x16x32_bf16 v[192:195], v[36:39], v[76:79], v[192:195]
    v_mfma_f32_16x16x32_bf16 v[196:199], v[40:43], v[76:79], v[196:199]
    v_mfma_f32_16x16x32_bf16 v[200:203], v[44:47], v[76:79], v[200:203]
    v_mfma_f32_16x16x32_bf16 v[204:207], v[48:51], v[76:79], v[204:207]
    v_mfma_f32_16x16x32_bf16 v[208:211], v[52:55], v[76:79], v[208:211]
    v_mfma_f32_16x16x32_bf16 v[212:215], v[36:39], v[84:87], v[212:215]
    v_mfma_f32_16x16x32_bf16 v[216:219], v[40:43], v[84:87], v[216:219]
    v_mfma_f32_16x16x32_bf16 v[220:223], v[44:47], v[84:87], v[220:223]
    v_mfma_f32_16x16x32_bf16 v[224:227], v[48:51], v[84:87], v[224:227]
    v_mfma_f32_16x16x32_bf16 v[228:231], v[52:55], v[84:87], v[228:231]
    s_branch G2_RED
G2_SHORT:
    s_waitcnt lgkmcnt(0)
    v_mfma_f32_16x16x32_bf16 v[152:155], v[16:19], v[88:91], v[152:155]
    v_mfma_f32_16x16x32_bf16 v[156:159], v[20:23], v[88:91], v[156:159]
    ds_read_b64_tr_b16 v[36:37], v11 offset:15360
    v_mfma_f32_16x16x32_bf16 v[160:163], v[24:27], v[88:91], v[160:163]
    v_mfma_f32_16x16x32_bf16 v[164:167], v[28:31], v[88:91], v[164:167]
    ds_read_b64_tr_b16 v[38:39], v11 offset:16640
    v_mfma_f32_16x16x32_bf16 v[168:171], v[32:35], v[88:91], v[168:171]
    v_mfma_f32_16x16x32_bf16 v[172:175], v[16:19], v[96:99], v[172:175]
    ds_read_b64_tr_b16 v[40:41], v11 offset:15392
    v_mfma_f32_16x16x32_bf16 v[176:179], v[20:23], v[96:99], v[176:179]
    v_mfma_f32_16x16x32_bf16 v[180:183], v[24:27], v[96:99], v[180:183]
    ds_read_b64_tr_b16 v[42:43], v11 offset:16672
    v_mfma_f32_16x16x32_bf16 v[184:187], v[28:31], v[96:99], v[184:187]
    v_mfma_f32_16x16x32_bf16 v[188:191], v[32:35], v[96:99], v[188:191]
    ds_read_b64_tr_b16 v[44:45], v11 offset:15424
    v_mfma_f32_16x16x32_bf16 v[192:195], v[16:19], v[104:107], v[192:195]
    v_mfma_f32_16x16x32_bf16 v[196:199], v[20:23], v[104:107], v[196:199]
    ds_read_b64_tr_b16 v[46:47], v11 offset:16704
    v_mfma_f32_16x16x32_bf16 v[200:203], v[24:27], v[104:107], v[200:203]
    v_mfma_f32_16x16x32_bf16 v[204:207], v[28:31], v[104:107], v[204:207]
    ds_read_b64_tr_b16 v[48:49], v11 offset:15456
    v_mfma_f32_16x16x32_bf16 v[208:211], v[32:35], v[104:107], v[208:211]
    v_mfma_f32_16x16x32_bf16 v[212:215], v[16:19], v[112:115], v[212:215]
    ds_read_b64_tr_b16 v[50:51], v11 offset:16736
    v_mfma_f32_16x16x32_bf16 v[216:219], v[20:23], v[112:115], v[216:219]
    v_mfma_f32_16x16x32_bf16 v[220:223], v[24:27], v[112:115], v[220:223]
    ds_read_b64_tr_b16 v[52:53], v11 offset:15488
    v_mfma_f32_16x16x32_bf16 v[224:227], v[28:31], v[112:115], v[224:227]
    v_mfma_f32_16x16x32_bf16 v[228:231], v[32:35], v[112:115], v[228:231]
    ds_read_b64_tr_b16 v[54:55], v11 offset:16768
    s_waitcnt lgkmcnt(0)
    s_waitcnt vmcnt(0)
    v_mfma_f32_16x16x32_bf16 v[152:155], v[36:39], v[92:95], v[152:155]
    v_mfma_f32_16x16x32_bf16 v[156:159], v[40:43], v[92:95], v[156:159]
    ds_read_b64_tr_b16 v[16:17], v11 offset:20480
    v_mfma_f32_16x16x32_bf16 v[160:163], v[44:47], v[92:95], v[160:163]
    v_mfma_f32_16x16x32_bf16 v[164:167], v[48:51], v[92:95], v[164:167]
    ds_read_b64_tr_b16 v[18:19], v11 offset:21760
    v_mfma_f32_16x16x32_bf16 v[168:171], v[52:55], v[92:95], v[168:171]
    v_mfma_f32_16x16x32_bf16 v[172:175], v[36:39], v[100:103], v[172:175]
    ds_read_b64_tr_b16 v[20:21], v11 offset:20512
    v_mfma_f32_16x16x32_bf16 v[176:179], v[40:43], v[100:103], v[176:179]
    v_mfma_f32_16x16x32_bf16 v[180:183], v[44:47], v[100:103], v[180:183]
    ds_read_b64_tr_b16 v[22:23], v11 offset:21792
    v_mfma_f32_16x16x32_bf16 v[184:187], v[48:51], v[100:103], v[184:187]
    v_mfma_f32_16x16x32_bf16 v[188:191], v[52:55], v[100:103], v[188:191]
    ds_read_b64_tr_b16 v[24:25], v11 offset:20544
    v_mfma_f32_16x16x32_bf16 v[192:195], v[36:39], v[108:111], v[192:195]
    v_mfma_f32_16x16x32_bf16 v[196:199], v[40:43], v[108:111], v[196:199]
    ds_read_b64_tr_b16 v[26:27], v11 offset:21824
    v_mfma_f32_16x16x32_bf16 v[200:203], v[44:47], v[108:111], v[200:203]
    v_mfma_f32_16x16x32_bf16 v[204:207], v[48:51], v[108:111], v[204:207]
    ds_read_b64_tr_b16 v[28:29], v11 offset:20576
    v_mfma_f32_16x16x32_bf16 v[208:211], v[52:55], v[108:111], v[208:211]
    v_mfma_f32_16x16x32_bf16 v[212:215], v[36:39], v[116:119], v[212:215]
    ds_read_b64_tr_b16 v[30:31], v11 offset:21856
    v_mfma_f32_16x16x32_bf16 v[216:219], v[40:43], v[116:119], v[216:219]
    v_mfma_f32_16x16x32_bf16 v[220:223], v[44:47], v[116:119], v[220:223]
    ds_read_b64_tr_b16 v[32:33], v11 offset:20608
    v_mfma_f32_16x16x32_bf16 v[224:227], v[48:51], v[116:119], v[224:227]
    v_mfma_f32_16x16x32_bf16 v[228:231], v[52:55], v[116:119], v[228:231]
    ds_read_b64_tr_b16 v[34:35], v11 offset:21888
    s_waitcnt lgkmcnt(0)
    v_mfma_f32_16x16x32_bf16 v[152:155], v[16:19], v[120:123], v[152:155]
    v_mfma_f32_16x16x32_bf16 v[156:159], v[20:23], v[120:123], v[156:159]
    ds_read_b64_tr_b16 v[36:37], v11 offset:25600
    v_mfma_f32_16x16x32_bf16 v[160:163], v[24:27], v[120:123], v[160:163]
    v_mfma_f32_16x16x32_bf16 v[164:167], v[28:31], v[120:123], v[164:167]
    ds_read_b64_tr_b16 v[38:39], v11 offset:26880
    v_mfma_f32_16x16x32_bf16 v[168:171], v[32:35], v[120:123], v[168:171]
    v_mfma_f32_16x16x32_bf16 v[172:175], v[16:19], v[128:131], v[172:175]
    ds_read_b64_tr_b16 v[40:41], v11 offset:25632
    v_mfma_f32_16x16x32_bf16 v[176:179], v[20:23], v[128:131], v[176:179]
    v_mfma_f32_16x16x32_bf16 v[180:183], v[24:27], v[128:131], v[180:183]
    ds_read_b64_tr_b16 v[42:43], v11 offset:26912
    v_mfma_f32_16x16x32_bf16 v[184:187], v[28:31], v[128:131], v[184:187]
    v_mfma_f32_16x16x32_bf16 v[188:191], v[32:35], v[128:131], v[188:191]
    ds_read_b64_tr_b16 v[44:45], v11 offset:25664
    v_mfma_f32_16x16x32_bf16 v[192:195], v[16:19], v[136:139], v[192:195]
    v_mfma_f32_16x16x32_bf16 v[196:199], v[20:23], v[136:139], v[196:199]
    ds_read_b64_tr_b16 v[46:47], v11 offset:26944
    v_mfma_f32_16x16x32_bf16 v[200:203], v[24:27], v[136:139], v[200:203]
    v_mfma_f32_16x16x32_bf16 v[204:207], v[28:31], v[136:139], v[204:207]
    ds_read_b64_tr_b16 v[48:49], v11 offset:25696
    v_mfma_f32_16x16x32_bf16 v[208:211], v[32:35], v[136:139], v[208:211]
    v_mfma_f32_16x16x32_bf16 v[212:215], v[16:19], v[144:147], v[212:215]
    ds_read_b64_tr_b16 v[50:51], v11 offset:26976
    v_mfma_f32_16x16x32_bf16 v[216:219], v[20:23], v[144:147], v[216:219]
    v_mfma_f32_16x16x32_bf16 v[220:223], v[24:27], v[144:147], v[220:223]
    ds_read_b64_tr_b16 v[52:53], v11 offset:25728
    v_mfma_f32_16x16x32_bf16 v[224:227], v[28:31], v[144:147], v[224:227]
    v_mfma_f32_16x16x32_bf16 v[228:231], v[32:35], v[144:147], v[228:231]
    ds_read_b64_tr_b16 v[54:55], v11 offset:27008
    s_waitcnt lgkmcnt(0)
    v_mfma_f32_16x16x32_bf16 v[152:155], v[36:39], v[124:127], v[152:155]
    v_mfma_f32_16x16x32_bf16 v[156:159], v[40:43], v[124:127], v[156:159]
    v_mfma_f32_16x16x32_bf16 v[160:163], v[44:47], v[124:127], v[160:163]
    v_mfma_f32_16x16x32_bf16 v[164:167], v[48:51], v[124:127], v[164:167]
    v_mfma_f32_16x16x32_bf16 v[168:171], v[52:55], v[124:127], v[168:171]
    v_mfma_f32_16x16x32_bf16 v[172:175], v[36:39], v[132:135], v[172:175]
    v_mfma_f32_16x16x32_bf16 v[176:179], v[40:43], v[132:135], v[176:179]
    v_mfma_f32_16x16x32_bf16 v[180:183], v[44:47], v[132:135], v[180:183]
    v_mfma_f32_16x16x32_bf16 v[184:187], v[48:51], v[132:135], v[184:187]
    v_mfma_f32_16x16x32_bf16 v[188:191], v[52:55], v[132:135], v[188:191]
    v_mfma_f32_16x16x32_bf16 v[192:195], v[36:39], v[140:143], v[192:195]
    v_mfma_f32_16x16x32_bf16 v[196:199], v[40:43], v[140:143], v[196:199]
    v_mfma_f32_16x16x32_bf16 v[200:203], v[44:47], v[140:143], v[200:203]
    v_mfma_f32_16x16x32_bf16 v[204:207], v[48:51], v[140:143], v[204:207]
    v_mfma_f32_16x16x32_bf16 v[208:211], v[52:55], v[140:143], v[208:211]
    v_mfma_f32_16x16x32_bf16 v[212:215], v[36:39], v[148:151], v[212:215]
    v_mfma_f32_16x16x32_bf16 v[216:219], v[40:43], v[148:151], v[216:219]
    v_mfma_f32_16x16x32_bf16 v[220:223], v[44:47], v[148:151], v[220:223]
    v_mfma_f32_16x16x32_bf16 v[224:227], v[48:51], v[148:151], v[224:227]
    v_mfma_f32_16x16x32_bf16 v[228:231], v[52:55], v[148:151], v[228:231]
G2_RED:
    v_lshlrev_b32 v12, 4, v1
    s_mul_i32 s24, s19, 20480
    v_add_u32 v13, s24, v12
    s_mul_i32 s24, s19, 5120
    v_add_u32 v14, s24, v12
    v_add_u32 v15, 40960, v14
    s_nop 7
    s_barrier
    ds_write_b128 v13, v[152:155] offset:0
    ds_write_b128 v13, v[156:159] offset:1024
    ds_write_b128 v13, v[160:163] offset:2048
    ds_write_b128 v13, v[164:167] offset:3072
    ds_write_b128 v13, v[168:171] offset:4096
    ds_write_b128 v13, v[172:175] offset:5120
    ds_write_b128 v13, v[176:179] offset:6144
    ds_write_b128 v13, v[180:183] offset:7168
    ds_write_b128 v13, v[184:187] offset:8192
    ds_write_b128 v13, v[188:191] offset:9216
    ds_write_b128 v13, v[192:195] offset:10240
    ds_write_b128 v13, v[196:199] offset:11264
    ds_write_b128 v13, v[200:203] offset:12288
    ds_write_b128 v13, v[204:207] offset:13312
    ds_write_b128 v13, v[208:211] offset:14336
    ds_write_b128 v13, v[212:215] offset:15360
    ds_write_b128 v13, v[216:219] offset:16384
    ds_write_b128 v13, v[220:223] offset:17408
    ds_write_b128 v13, v[224:227] offset:18432
    ds_write_b128 v13, v[228:231] offset:19456
    s_waitcnt lgkmcnt(0)
    s_barrier
    ds_read_b128 v[16:19], v14 offset:0
    ds_read_b128 v[20:23], v14 offset:1024
    ds_read_b128 v[24:27], v14 offset:2048
    ds_read_b128 v[28:31], v14 offset:3072
    ds_read_b128 v[32:35], v14 offset:4096
    ds_read_b128 v[36:39], v14 offset:20480
    ds_read_b128 v[40:43], v14 offset:21504
    ds_read_b128 v[44:47], v14 offset:22528
    ds_read_b128 v[48:51], v14 offset:23552
    ds_read_b128 v[52:55], v14 offset:24576
    ds_read_b128 v[56:59], v15 offset:0
    ds_read_b128 v[60:63], v15 offset:1024
    ds_read_b128 v[64:67], v15 offset:2048
    ds_read_b128 v[68:71], v15 offset:3072
    ds_read_b128 v[72:75], v15 offset:4096
    ds_read_b128 v[76:79], v15 offset:20480
    ds_read_b128 v[80:83], v15 offset:21504
    ds_read_b128 v[84:87], v15 offset:22528
    ds_read_b128 v[88:91], v15 offset:23552
    ds_read_b128 v[92:95], v15 offset:24576
    v_and_b32 v12, 15, v1
    s_lshl_b32 s24, s19, 4
    s_add_u32 s24, s24, s20
    v_add_u32 v12, s24, v12
    v_mul_u32_u24 v12, 0x500, v12
    v_lshrrev_b32 v13, 4, v1
    v_lshlrev_b32 v13, 3, v13
    s_lshl_b32 s24, s21, 1
    v_add_u32 v13, s24, v13
    v_add_u32 v12, v12, v13
    s_waitcnt lgkmcnt(0)
    v_pk_add_f32 v[16:17], v[16:17], v[36:37]
    v_pk_add_f32 v[16:17], v[16:17], v[56:57]
    v_pk_add_f32 v[16:17], v[16:17], v[76:77]
    v_pk_add_f32 v[18:19], v[18:19], v[38:39]
    v_pk_add_f32 v[18:19], v[18:19], v[58:59]
    v_pk_add_f32 v[18:19], v[18:19], v[78:79]
    v_pk_add_f32 v[20:21], v[20:21], v[40:41]
    v_pk_add_f32 v[20:21], v[20:21], v[60:61]
    v_pk_add_f32 v[20:21], v[20:21], v[80:81]
    v_pk_add_f32 v[22:23], v[22:23], v[42:43]
    v_pk_add_f32 v[22:23], v[22:23], v[62:63]
    v_pk_add_f32 v[22:23], v[22:23], v[82:83]
    v_pk_add_f32 v[24:25], v[24:25], v[44:45]
    v_pk_add_f32 v[24:25], v[24:25], v[64:65]
    v_pk_add_f32 v[24:25], v[24:25], v[84:85]
    v_pk_add_f32 v[26:27], v[26:27], v[46:47]
    v_pk_add_f32 v[26:27], v[26:27], v[66:67]
    v_pk_add_f32 v[26:27], v[26:27], v[86:87]
    v_pk_add_f32 v[28:29], v[28:29], v[48:49]
    v_pk_add_f32 v[28:29], v[28:29], v[68:69]
    v_pk_add_f32 v[28:29], v[28:29], v[88:89]
    v_pk_add_f32 v[30:31], v[30:31], v[50:51]
    v_pk_add_f32 v[30:31], v[30:31], v[70:71]
    v_pk_add_f32 v[30:31], v[30:31], v[90:91]
    v_pk_add_f32 v[32:33], v[32:33], v[52:53]
    v_pk_add_f32 v[32:33], v[32:33], v[72:73]
    v_pk_add_f32 v[32:33], v[32:33], v[92:93]
    v_pk_add_f32 v[34:35], v[34:35], v[54:55]
    v_pk_add_f32 v[34:35], v[34:35], v[74:75]
    v_pk_add_f32 v[34:35], v[34:35], v[94:95]
    v_cvt_pk_bf16_f32 v100, v16, v17
    v_cvt_pk_bf16_f32 v101, v18, v19
    v_cvt_pk_bf16_f32 v102, v20, v21
    v_cvt_pk_bf16_f32 v103, v22, v23
    v_cvt_pk_bf16_f32 v104, v24, v25
    v_cvt_pk_bf16_f32 v105, v26, v27
    v_cvt_pk_bf16_f32 v106, v28, v29
    v_cvt_pk_bf16_f32 v107, v30, v31
    v_cvt_pk_bf16_f32 v108, v32, v33
    v_cvt_pk_bf16_f32 v109, v34, v35
    buffer_store_dwordx2 v[100:101], v12, s[12:15], 0 offen offset:0
    buffer_store_dwordx2 v[102:103], v12, s[12:15], 0 offen offset:32
    buffer_store_dwordx2 v[104:105], v12, s[12:15], 0 offen offset:64
    buffer_store_dwordx2 v[106:107], v12, s[12:15], 0 offen offset:96
    buffer_store_dwordx2 v[108:109], v12, s[12:15], 0 offen offset:128
    s_waitcnt vmcnt(0)
G2_END:
    s_endpgm
.section .rodata,"a"
.p2align 6
.amdhsa_kernel gemm2_kernel
  .amdhsa_next_free_vgpr 232
  .amdhsa_next_free_sgpr 64
  .amdhsa_accum_offset 232
  .amdhsa_group_segment_fixed_size 0
  .amdhsa_kernarg_size 48
  .amdhsa_user_sgpr_count 2
  .amdhsa_user_sgpr_kernarg_segment_ptr 1
  .amdhsa_system_sgpr_workgroup_id_x 1
.end_amdhsa_kernel
```
